```python
import torch

def _softmax(x, axis=-1):
    return torch.softmax(x, dim=axis)
def _gelu(x):
    return torch.nn.functional.gelu(x, approximate="tanh")
def _silu(x):
    return torch.nn.functional.silu(x)
def _sigmoid(x):
    return torch.sigmoid(x)
def _layernorm(x, axis=-1, eps=1e-5):
    m = x.mean(dim=axis, keepdim=True)
    v = x.var(dim=axis, keepdim=True, unbiased=False)
    return (x - m) / torch.sqrt(v + eps)
def _scatter_add(tgt, idx, src, axis=0):
    return tgt.clone().index_add_(axis, idx, src)
def _segment_sum(src, seg, n):
    out = torch.zeros((n,) + src.shape[1:], dtype=src.dtype)
    return out.index_add_(0, seg, src)
def _pad(x, pw):
    flat = tuple(v for pair in reversed(pw) for v in pair)
    return torch.nn.functional.pad(x, flat)

kernel_name = 'standalone__dense_activation_silu__prompt'

def setup_inputs():

    _w = (lambda a: (lambda t: t.to(torch.bfloat16) if t.is_floating_point() else t)(torch.as_tensor(a)))
    B, S, D, F = 1, 2048, 640, 1536
    return {
        "x": _w((lambda *s: torch.randn(*s, dtype=torch.bfloat16) * 0.1)(B, S, D)),
        "w1": _w((lambda *s: torch.randn(*s, dtype=torch.bfloat16) * 3.2)(D, F) * (D ** -0.5)),
        "w2": _w((lambda *s: torch.randn(*s, dtype=torch.bfloat16) * 3.2)(F, D) * (F ** -0.5)),
    }

def reference(x, w1, w2):
    h = torch.einsum("bsd,df->bsf", x, w1)
    h = _silu(h)
    out = torch.einsum("bsf,fd->bsd", h, w2)
    return out
```

```asm
; @launch grid=(256,1,1) block=(256,1,1) lds=163840
.amdgcn_target "amdgcn-amd-amdhsa--gfx950"
.text
.globl standalone__dense_activation_silu__prompt_kernel
.p2align 8
.type standalone__dense_activation_silu__prompt_kernel,@function
standalone__dense_activation_silu__prompt_kernel:
    s_cmp_ge_u32 s2, 256
    s_cbranch_scc1 L_end
    s_load_dwordx2 s[4:5], s[0:1], 0
    s_load_dwordx2 s[8:9], s[0:1], 8
    s_load_dwordx2 s[12:13], s[0:1], 16
    s_load_dwordx2 s[16:17], s[0:1], 24
    s_load_dwordx2 s[24:25], s[0:1], 40
    s_getpc_b64 s[34:35]
L_pc_L_end:
    v_lshrrev_b32 v221, 5, v0
    s_bfe_u32 s74, s2, 0x50003
    s_lshl_b32 s74, s74, 10
    v_lshl_add_u32 v221, v221, 7, s74
    v_min_u32 v221, L_code_end-L_pc_L_end-4, v221
    global_load_dword v221, v221, s[34:35]
    v_lshrrev_b32 v2, 6, v0
    v_and_b32 v1, 63, v0
    s_and_b32 s31, s2, 7
    v_readfirstlane_b32 s28, v2
    s_bfe_u32 s29, s2, 0x30003
    s_lshr_b32 s30, s2, 6
    s_mov_b32 s6, 2621440
    s_mov_b32 s7, 0x00020000
    s_mov_b32 s10, 1966080
    s_mov_b32 s11, 0x00020000
    s_lshr_b32 s32, s31, 1
    s_lshl_b32 s32, s32, 2
    s_add_u32 s32, s32, s30
    s_and_b32 s33, s31, 1
    s_lshl_b32 s33, s33, 3
    s_add_u32 s33, s33, s29
    v_lshrrev_b32 v2, 3, v1
    v_mul_u32_u24 v2, 1280, v2
    v_and_b32 v3, 7, v1
    v_lshrrev_b32 v4, 4, v1
    v_xor_b32 v3, v3, v4
    v_lshl_add_u32 v200, v3, 4, v2
    v_xor_b32 v3, 4, v3
    v_lshl_add_u32 v201, v3, 4, v2
    v_add_u32 v202, 18432, v200
    v_add_u32 v203, 27648, v201
    v_add_u32 v201, 9216, v201
    v_lshrrev_b32 v2, 3, v1
    v_mul_u32_u24 v2, 3072, v2
    v_lshrrev_b32 v3, 2, v1
    v_and_b32 v3, 4, v3
    v_and_b32 v4, 7, v1
    v_xor_b32 v3, v3, v4
    s_and_b32 s74, s33, 1
    s_lshl_b32 s74, s74, 6
    v_lshl_add_u32 v2, v3, 4, v2
    v_add_u32 v204, s74, v2
    v_add_u32 v205, 23552, v204
    s_add_u32 s64, s29, s30
    s_and_b32 s64, s64, 3
    s_mul_i32 s64, s64, 5
    s_add_u32 s64, s64, 1
    s_lshr_b32 s64, s64, 1
    s_lshl_b32 s65, s32, 2
    s_add_u32 s65, s65, s28
    s_mul_i32 s65, s65, 40960
    s_mul_i32 s66, s28, 49152
    s_mul_i32 s75, s33, 192
    s_add_u32 s66, s66, s75
    s_lshl_b32 s40, s64, 7
    s_mul_i32 s50, s64, 196608
    s_add_u32 s40, s40, s65
    s_add_u32 s50, s50, s66
    s_lshl_b32 s36, s28, 12
    s_lshl_b32 s3, s28, 11
    s_add_u32 s3, s3, 65536
    s_waitcnt lgkmcnt(0)
    s_add_u32 m0, s3, 0
    s_nop 0
    buffer_load_dwordx4 v204, s[8:11], s50 offen offset:0 lds
    buffer_load_dwordx4 v205, s[8:11], s50 offen offset:1024 lds
    s_add_u32 m0, s36, 0
    s_nop 0
    buffer_load_dwordx4 v200, s[4:7], s40 offen offset:0 lds
    buffer_load_dwordx4 v201, s[4:7], s40 offen offset:1024 lds
    buffer_load_dwordx4 v202, s[4:7], s40 offen offset:2048 lds
    buffer_load_dwordx4 v203, s[4:7], s40 offen offset:3072 lds
    v_mov_b32 v225, 8945664
    s_mov_b32 s14, 1966080
    s_mov_b32 s15, 0x00020000
    s_mov_b32 s18, 2621440
    s_mov_b32 s19, 0x00020000
    s_mov_b32 s26, 16777216
    s_mov_b32 s27, 0x00020000
    s_add_u32 s24, s24, 251658240
    s_addc_u32 s25, s25, 0
    s_and_b32 s100, s33, 7
    s_lshr_b32 s101, s33, 3
    s_add_u32 s64, s64, 1
    s_cmp_eq_u32 s64, 10
    s_cselect_b32 s64, 0, s64
    s_lshl_b32 s41, s64, 7
    s_mul_i32 s51, s64, 196608
    s_add_u32 s41, s41, s65
    s_add_u32 s51, s51, s66
    v_lshrrev_b32 v2, 3, v1
    v_and_b32 v3, 7, v1
    s_cmp_ge_u32 s2, 160
    s_cselect_b32 s74, 5, 12
    s_cselect_b32 s35, 2, 3
    s_cselect_b32 s34, 160, 0
    s_lshl_b32 s74, s74, 8
    v_mul_u32_u24 v214, s74, v2
    s_sub_u32 s34, s2, s34
    s_lshr_b32 s60, s34, s35
    v_lshl_add_u32 v214, v3, 4, v214
    s_lshl2_add_u32 s35, s60, s28
    s_mul_i32 s39, s35, s74
    s_lshl_b32 s39, s39, 3
    buffer_load_dwordx2 v[22:23], v225, s[24:27], 0 offen sc1
    s_cmp_ge_u32 s2, 160
    s_cbranch_scc1 L_pp2
    s_and_b32 s34, s2, 7
    s_mul_i32 s34, s34, 384
    s_add_u32 s39, s39, s34
    buffer_load_dwordx4 v[168:171], v214, s[8:11], s39 offen offset:128
    s_branch L_pp3
L_pp2:
    s_and_b32 s34, s2, 1
    s_mul_i32 s34, s34, 983040
    s_add_u32 s39, s39, s34
    s_and_b32 s34, s2, 2
    s_mul_i32 s34, s34, 320
    s_add_u32 s39, s39, s34
    buffer_load_dwordx4 v[168:171], v214, s[12:15], s39 offen offset:512
L_pp3:
    s_add_u32 m0, s3, 8192
    s_nop 0
    buffer_load_dwordx4 v204, s[8:11], s51 offen offset:0 lds
    buffer_load_dwordx4 v205, s[8:11], s51 offen offset:1024 lds
    s_add_u32 s64, s64, 1
    s_cmp_eq_u32 s64, 10
    s_cselect_b32 s64, 0, s64
    s_lshl_b32 s42, s64, 7
    s_mul_i32 s52, s64, 196608
    s_add_u32 s42, s42, s65
    s_add_u32 s52, s52, s66
    s_add_u32 s64, s64, 1
    s_cmp_eq_u32 s64, 10
    s_cselect_b32 s64, 0, s64
    s_lshl_b32 s43, s64, 7
    s_mul_i32 s53, s64, 196608
    s_add_u32 s43, s43, s65
    s_add_u32 s53, s53, s66
    s_add_u32 s64, s64, 1
    s_cmp_eq_u32 s64, 10
    s_cselect_b32 s64, 0, s64
    s_lshl_b32 s44, s64, 7
    s_mul_i32 s54, s64, 196608
    s_add_u32 s44, s44, s65
    s_add_u32 s54, s54, s66
    s_add_u32 s64, s64, 1
    s_cmp_eq_u32 s64, 10
    s_cselect_b32 s64, 0, s64
    s_lshl_b32 s45, s64, 7
    s_mul_i32 s55, s64, 196608
    s_add_u32 s45, s45, s65
    s_add_u32 s55, s55, s66
    s_add_u32 s64, s64, 1
    s_cmp_eq_u32 s64, 10
    s_cselect_b32 s64, 0, s64
    s_lshl_b32 s46, s64, 7
    s_mul_i32 s56, s64, 196608
    s_add_u32 s46, s46, s65
    s_add_u32 s56, s56, s66
    s_add_u32 s64, s64, 1
    s_cmp_eq_u32 s64, 10
    s_cselect_b32 s64, 0, s64
    s_lshl_b32 s47, s64, 7
    s_mul_i32 s57, s64, 196608
    s_add_u32 s47, s47, s65
    s_add_u32 s57, s57, s66
    s_add_u32 s64, s64, 1
    s_cmp_eq_u32 s64, 10
    s_cselect_b32 s64, 0, s64
    s_lshl_b32 s48, s64, 7
    s_mul_i32 s58, s64, 196608
    s_add_u32 s48, s48, s65
    s_add_u32 s58, s58, s66
    s_add_u32 s64, s64, 1
    s_cmp_eq_u32 s64, 10
    s_cselect_b32 s64, 0, s64
    s_lshl_b32 s49, s64, 7
    s_mul_i32 s59, s64, 196608
    s_add_u32 s49, s49, s65
    s_add_u32 s59, s59, s66
    s_cmp_ge_u32 s2, 160
    s_cselect_b32 s34, 1, 2
    s_cselect_b32 s35, 6, 5
    s_cselect_b32 s74, 2, 0
    v_and_b32 v2, 7, v1
    v_lshrrev_b32 v2, s34, v2
    v_lshrrev_b32 v3, 3, v1
    s_lshl_b32 s35, s35, 13
    s_and_b32 s74, s74, s28
    s_lshl_b32 s74, s74, 1
    v_xor_b32 v3, s74, v3
    v_sub_u32 v3, v3, v2
    v_lshlrev_b32 v3, s34, v3
    v_and_b32 v4, 7, v1
    v_add_u32 v3, v3, v4
    v_mul_u32_u24 v2, s35, v2
    v_lshl_add_u32 v219, v3, 4, v2
    s_lshl2_add_u32 s35, s60, s28
    s_add_u32 s34, s34, 7
    s_lshl_b32 s35, s35, s34
    s_and_b32 s34, s2, 7
    s_mul_i32 s74, s34, 20
    s_add_u32 s61, s60, s74
    s_mul_i32 s34, s34, 81920
    s_and_b32 s74, s2, 3
    s_mul_i32 s75, s74, 24
    s_add_u32 s60, s60, s75
    s_add_u32 s60, s60, 160
    s_mul_i32 s74, s74, 5
    s_and_b32 s74, s74, 9
    s_mul_i32 s74, s74, 24576
    s_add_u32 s74, s74, 1048576
    s_cmp_ge_u32 s2, 160
    s_cselect_b32 s61, s60, s61
    s_cselect_b32 s34, s74, s34
    s_add_u32 s60, s34, s35
    s_add_u32 s60, s60, 6291456
    v_and_b32 v2, 31, v1
    v_lshlrev_b32 v3, 7, v2
    s_lshl_b32 s34, s101, 11
    s_xor_b32 s34, s34, s36
    v_xor_b32 v3, s34, v3
    v_bfe_u32 v4, v1, 1, 3
    v_lshrrev_b32 v5, 5, v1
    v_xor_b32 v4, v4, v5
    v_xor_b32 v5, 0, v4
    v_lshl_add_u32 v208, v5, 4, v3
    v_xor_b32 v5, 2, v4
    v_lshl_add_u32 v209, v5, 4, v3
    v_xor_b32 v5, 4, v4
    v_lshl_add_u32 v210, v5, 4, v3
    v_xor_b32 v5, 6, v4
    v_lshl_add_u32 v211, v5, 4, v3
    v_lshrrev_b32 v2, 5, v1
    v_bfe_u32 v3, v1, 2, 2
    v_lshl_add_u32 v2, v2, 3, v3
    v_bfe_u32 v3, v1, 4, 1
    v_and_b32 v4, 3, v1
    v_lshlrev_b32 v4, 3, v4
    v_lshl_add_u32 v3, v3, 5, v4
    v_lshl_add_u32 v17, v2, 6, v3
    v_add_u32 v17, 98304, v17
    v_lshl_add_u32 v2, v2, 7, v3
    v_bfe_u32 v3, v1, 3, 1
    v_lshl_add_u32 v2, v3, 6, v2
    v_add_u32 v212, 65536, v2
    v_xor_b32 v237, 64, v212
    s_mul_i32 s37, s33, 40960
    s_lshl_b32 s34, s65, 5
    s_sub_u32 s37, s37, s34
    s_lshl_b32 s73, s28, 10
    s_add_u32 s73, s73, 98304
    s_add_u32 s37, s37, s73
    s_add_u32 s37, s37, 6193152
    s_mov_b32 s62, 0xbfb8aa3b
    s_mov_b32 s63, 0xbfb8aa3b
    v_lshlrev_b32 v6, 4, v1
    v_add_u32 v7, 0x1000, v6
    v_lshrrev_b32 v2, 3, v1
    v_and_b32 v3, 2, v2
    v_mul_u32_u24 v2, 1280, v2
    v_and_b32 v4, 7, v1
    v_xor_b32 v3, v3, v4
    v_lshl_add_u32 v10, v3, 4, v2
    v_xor_b32 v12, 64, v10
    v_add_u32 v11, 9216, v10
    v_add_u32 v13, 27648, v12
    v_add_u32 v12, 18432, v12
    v_bfe_u32 v2, v1, 2, 2
    v_lshrrev_b32 v3, 5, v1
    v_lshl_add_u32 v2, v3, 2, v2
    v_and_b32 v3, 16, v1
    v_add_u32 v2, v2, v3
    v_and_b32 v4, 3, v1
    v_lshlrev_b32 v4, 3, v4
    v_lshl_add_u32 v228, v2, 7, v4
    v_lshrrev_b32 v3, 2, v3
    v_xor_b32 v2, v2, v3
    v_lshl_add_u32 v236, v2, 5, v4
    v_add_u32 v236, 139264, v236
    v_and_b32 v2, 24, v1
    v_lshl_add_u32 v228, v2, 2, v228
    v_xor_b32 v229, 32, v228
    v_xor_b32 v230, 64, v228
    v_xor_b32 v231, 96, v228
    v_xor_b32 v232, 65536, v228
    v_xor_b32 v233, 65568, v228
    v_xor_b32 v234, 65600, v228
    v_xor_b32 v235, 65632, v228
    v_and_b32 v2, 0x2f0, v6
    v_and_b32 v3, 16, v1
    v_lshl_add_u32 v9, v3, 6, v2
    s_lshr_b32 s34, s28, 1
    s_add_u32 s34, s34, s100
    s_and_b32 s34, s34, 7
    s_mul_i32 s0, s34, 3
    s_and_b32 s34, s34, 1
    s_add_u32 s0, s0, s34
    s_and_b32 s34, s28, 1
    s_add_u32 s0, s0, s34
    s_add_u32 s34, s28, s100
    s_and_b32 s34, s34, 7
    s_mul_i32 s1, s34, 3
    s_andn2_b32 s34, 1, s34
    s_lshl1_add_u32 s1, s34, s1
    s_lshl1_add_u32 s65, s100, s101
    s_mul_i32 s65, s65, 24576
    s_add_u32 s65, s65, 7340032
    s_lshr_b32 s35, s100, 2
    s_add_u32 s35, s35, s100
    s_lshl_b32 s75, s35, 7
    s_mul_i32 s64, s101, 983040
    s_add_u32 s64, s64, s75
    s_lshl2_add_u32 s34, s32, s28
    s_lshl1_add_u32 s34, s34, s101
    s_xor_b32 s74, s34, 1
    s_mul_i32 s72, s74, 20480
    s_lshl_b32 s22, s34, 10
    s_lshl3_add_u32 s67, s34, s100
    s_lshl3_add_u32 s66, s74, s100
    s_mul_i32 s38, s67, 6144
    s_mul_i32 s34, s34, 49152
    s_add_u32 s35, s100, 1
    s_and_b32 s35, s35, 7
    s_mul_i32 s35, s35, 6144
    s_add_u32 s68, s35, s34
    s_add_u32 s35, s100, 2
    s_and_b32 s35, s35, 7
    s_mul_i32 s35, s35, 6144
    s_add_u32 s69, s35, s34
    s_add_u32 s35, s100, 3
    s_and_b32 s35, s35, 7
    s_mul_i32 s35, s35, 6144
    s_add_u32 s70, s35, s34
    s_add_u32 s35, s100, 4
    s_and_b32 s35, s35, 7
    s_mul_i32 s35, s35, 6144
    s_add_u32 s71, s35, s34
    s_add_u32 s35, s100, 5
    s_and_b32 s35, s35, 7
    s_mul_i32 s35, s35, 6144
    s_add_u32 s29, s35, s34
    s_add_u32 s35, s100, 6
    s_and_b32 s35, s35, 7
    s_mul_i32 s35, s35, 6144
    s_add_u32 s30, s35, s34
    s_add_u32 s35, s100, 7
    s_and_b32 s35, s35, 7
    s_mul_i32 s35, s35, 6144
    s_add_u32 s31, s35, s34
    s_lshl_b32 s67, s67, 12
    s_add_u32 s67, s67, 9437184
    s_lshl_b32 s66, s66, 12
    s_add_u32 s66, s66, 9437184
    s_add_u32 s72, s72, s75
    v_and_b32 v2, 15, v1
    v_mul_u32_u24 v2, 1280, v2
    v_lshrrev_b32 v3, 4, v1
    v_lshl_add_u32 v19, v3, 3, v2
    s_and_b32 s34, s100, 3
    s_mul_i32 s34, s34, 96
    v_subrev_u32 v19, s34, v19
    v_add_u32 v19, 0x200, v19
    v_lshrrev_b32 v3, 5, v1
    v_lshl_add_u32 v2, v3, 4, v2
    v_and_b32 v3, 16, v1
    v_lshl_add_u32 v18, v3, 1, v2
    s_lshl_b32 s34, s61, 7
    s_add_u32 s34, s34, 8912896
    v_lshrrev_b32 v2, 3, v0
    v_lshl_add_u32 v2, v2, 25, v6
    v_add_u32 v223, s34, v2
    s_mul_i32 s34, s28, 11
    v_min_u32 v2, 10, v1
    v_add_u32 v2, s34, v2
    s_lshr_b32 s34, s33, 1
    s_mul_i32 s34, s34, 20
    s_lshr_b32 s35, s100, 2
    s_lshl1_add_u32 s35, s35, s101
    s_mul_i32 s35, s35, 24
    s_add_u32 s35, s35, 140
    v_add_u32 v3, s35, v2
    v_cmp_gt_u32 vcc, 20, v2
    v_add_u32 v2, s34, v2
    v_cndmask_b32 v2, v3, v2, vcc
    v_lshlrev_b32 v2, 7, v2
    v_add_u32 v222, 8912896, v2
    s_add_u32 s34, s22, 8388608
    s_lshl_b32 s35, s100, 7
    s_add_u32 s22, s34, s35
    s_add_u32 s23, s22, 262144
    v_lshlrev_b32 v226, 26, v1
    v_and_b32 v2, 7, v1
    v_max_u32 v2, 1, v2
    v_lshl_add_u32 v5, v2, 3, s22
    v_sub_u32 v3, s100, v2
    v_and_b32 v3, 7, v3
    v_lshlrev_b32 v3, 7, v3
    v_lshl_add_u32 v3, v2, 3, v3
    v_lshrrev_b32 v2, 3, v1
    v_lshl_add_u32 v3, v2, 26, v3
    v_add_u32 v224, s34, v3
    s_add_u32 m0, s36, 16384
    s_nop 0
    buffer_load_dwordx4 v200, s[4:7], s41 offen offset:0 lds
    buffer_load_dwordx4 v201, s[4:7], s41 offen offset:1024 lds
    buffer_load_dwordx4 v202, s[4:7], s41 offen offset:2048 lds
    buffer_load_dwordx4 v203, s[4:7], s41 offen offset:3072 lds
    buffer_load_dword v221, v5, s[24:27], 0 offen sc1
    buffer_load_dword v221, v223, s[24:27], 0 offen sc1
    s_lshl2_add_u32 s34, s2, s28
    s_mul_i32 s34, s34, 1920
    v_min_u32 v2, 14, v1
    v_lshlrev_b32 v2, 7, v2
    buffer_load_dword v221, v2, s[12:15], s34 offen
    s_add_u32 m0, s3, 16384
    s_nop 0
    buffer_load_dwordx4 v204, s[8:11], s52 offen offset:0 lds
    buffer_load_dwordx4 v205, s[8:11], s52 offen offset:1024 lds
    s_add_u32 m0, s36, 32768
    s_nop 0
    buffer_load_dwordx4 v200, s[4:7], s42 offen offset:0 lds
    buffer_load_dwordx4 v201, s[4:7], s42 offen offset:1024 lds
    buffer_load_dwordx4 v202, s[4:7], s42 offen offset:2048 lds
    buffer_load_dwordx4 v203, s[4:7], s42 offen offset:3072 lds
    s_waitcnt vmcnt(15)
    buffer_store_dwordx4 v[168:171], v219, s[24:27], s60 offen sc1
    s_barrier
    ds_read_b128 a[0:3], v208 offset:0
    ds_read_b64_tr_b16 v[80:81], v212 offset:0
    ds_read_b64_tr_b16 v[82:83], v212 offset:512
    ds_read_b64_tr_b16 v[84:85], v237 offset:0
    ds_read_b64_tr_b16 v[86:87], v237 offset:512
    ds_read_b128 a[4:7], v209 offset:0
    ds_read_b64_tr_b16 v[88:89], v212 offset:2048
    ds_read_b64_tr_b16 v[90:91], v212 offset:2560
    ds_read_b64_tr_b16 v[92:93], v237 offset:2048
    ds_read_b64_tr_b16 v[94:95], v237 offset:2560
    ds_read_b128 a[8:11], v210 offset:0
    ds_read_b64_tr_b16 v[96:97], v212 offset:4096
    ds_read_b64_tr_b16 v[98:99], v212 offset:4608
    ds_read_b64_tr_b16 v[100:101], v237 offset:4096
    ds_read_b64_tr_b16 v[102:103], v237 offset:4608
    s_waitcnt lgkmcnt(12)
    v_mfma_f32_32x32x16_bf16 v[32:47], v[80:83], a[0:3], 0
    ds_read_b128 a[12:15], v211 offset:0
    ds_read_b64_tr_b16 v[104:105], v212 offset:6144
    ds_read_b64_tr_b16 v[106:107], v212 offset:6656
    s_waitcnt lgkmcnt(13)
    v_mfma_f32_32x32x16_bf16 v[48:63], v[84:87], a[0:3], 0
    ds_read_b64_tr_b16 v[108:109], v237 offset:6144
    ds_read_b64_tr_b16 v[110:111], v237 offset:6656
    s_waitcnt lgkmcnt(12)
    v_mfma_f32_32x32x16_bf16 v[32:47], v[88:91], a[4:7], v[32:47]
    s_waitcnt vmcnt(10)
    s_barrier
    ds_read_b128 a[16:19], v208 offset:16384
    ds_read_b64_tr_b16 v[80:81], v212 offset:8192
    ds_read_b64_tr_b16 v[82:83], v212 offset:8704
    s_add_u32 m0, s3, 24576
    s_waitcnt lgkmcnt(13)
    v_mfma_f32_32x32x16_bf16 v[48:63], v[92:95], a[4:7], v[48:63]
    ds_read_b64_tr_b16 v[84:85], v237 offset:8192
    ds_read_b64_tr_b16 v[86:87], v237 offset:8704
    buffer_load_dwordx4 v204, s[8:11], s53 offen offset:0 lds
    s_waitcnt lgkmcnt(12)
    v_mfma_f32_32x32x16_bf16 v[32:47], v[96:99], a[8:11], v[32:47]
    ds_read_b128 a[20:23], v209 offset:16384
    ds_read_b64_tr_b16 v[88:89], v212 offset:10240
    ds_read_b64_tr_b16 v[90:91], v212 offset:10752
    buffer_load_dwordx4 v205, s[8:11], s53 offen offset:1024 lds
    s_add_u32 m0, s36, 49152
    s_waitcnt lgkmcnt(13)
    v_mfma_f32_32x32x16_bf16 v[48:63], v[100:103], a[8:11], v[48:63]
    ds_read_b64_tr_b16 v[92:93], v237 offset:10240
    ds_read_b64_tr_b16 v[94:95], v237 offset:10752
    buffer_load_dwordx4 v200, s[4:7], s43 offen offset:0 lds
    s_waitcnt lgkmcnt(12)
    v_mfma_f32_32x32x16_bf16 v[32:47], v[104:107], a[12:15], v[32:47]
    ds_read_b128 a[24:27], v210 offset:16384
    ds_read_b64_tr_b16 v[96:97], v212 offset:12288
    ds_read_b64_tr_b16 v[98:99], v212 offset:12800
    buffer_load_dwordx4 v201, s[4:7], s43 offen offset:1024 lds
    s_waitcnt lgkmcnt(13)
    v_mfma_f32_32x32x16_bf16 v[48:63], v[108:111], a[12:15], v[48:63]
    ds_read_b64_tr_b16 v[100:101], v237 offset:12288
    ds_read_b64_tr_b16 v[102:103], v237 offset:12800
    buffer_load_dwordx4 v202, s[4:7], s43 offen offset:2048 lds
    s_waitcnt lgkmcnt(12)
    v_mfma_f32_32x32x16_bf16 v[32:47], v[80:83], a[16:19], v[32:47]
    ds_read_b128 a[28:31], v211 offset:16384
    ds_read_b64_tr_b16 v[104:105], v212 offset:14336
    ds_read_b64_tr_b16 v[106:107], v212 offset:14848
    buffer_load_dwordx4 v203, s[4:7], s43 offen offset:3072 lds
    s_waitcnt lgkmcnt(13)
    v_mfma_f32_32x32x16_bf16 v[48:63], v[84:87], a[16:19], v[48:63]
    ds_read_b64_tr_b16 v[108:109], v237 offset:14336
    ds_read_b64_tr_b16 v[110:111], v237 offset:14848
    s_waitcnt lgkmcnt(12)
    v_mfma_f32_32x32x16_bf16 v[32:47], v[88:91], a[20:23], v[32:47]
    s_waitcnt vmcnt(6)
    s_barrier
    ds_read_b128 a[32:35], v208 offset:32768
    ds_read_b64_tr_b16 v[80:81], v212 offset:16384
    ds_read_b64_tr_b16 v[82:83], v212 offset:16896
    v_add_u32 v22, 0x7f4a7c15, v22
    v_add_u32 v23, 0x9e3779b9, v23
    buffer_store_dwordx4 v[22:25], v223, s[24:27], 0 offen sc1
    v_readfirstlane_b32 s20, v22
    v_readfirstlane_b32 s21, v23
    s_add_u32 m0, s3, 0
    s_waitcnt lgkmcnt(13)
    v_mfma_f32_32x32x16_bf16 v[48:63], v[92:95], a[20:23], v[48:63]
    ds_read_b64_tr_b16 v[84:85], v237 offset:16384
    ds_read_b64_tr_b16 v[86:87], v237 offset:16896
    buffer_load_dwordx4 v204, s[8:11], s54 offen offset:0 lds
    s_waitcnt lgkmcnt(12)
    v_mfma_f32_32x32x16_bf16 v[32:47], v[96:99], a[24:27], v[32:47]
    ds_read_b128 a[36:39], v209 offset:32768
    ds_read_b64_tr_b16 v[88:89], v212 offset:18432
    ds_read_b64_tr_b16 v[90:91], v212 offset:18944
    buffer_load_dwordx4 v205, s[8:11], s54 offen offset:1024 lds
    s_add_u32 m0, s36, 0
    s_waitcnt lgkmcnt(13)
    v_mfma_f32_32x32x16_bf16 v[48:63], v[100:103], a[24:27], v[48:63]
    ds_read_b64_tr_b16 v[92:93], v237 offset:18432
    ds_read_b64_tr_b16 v[94:95], v237 offset:18944
    buffer_load_dwordx4 v200, s[4:7], s44 offen offset:0 lds
    s_waitcnt lgkmcnt(12)
    v_mfma_f32_32x32x16_bf16 v[32:47], v[104:107], a[28:31], v[32:47]
    ds_read_b128 a[40:43], v210 offset:32768
    ds_read_b64_tr_b16 v[96:97], v212 offset:20480
    ds_read_b64_tr_b16 v[98:99], v212 offset:20992
    buffer_load_dwordx4 v201, s[4:7], s44 offen offset:1024 lds
    s_waitcnt lgkmcnt(13)
    v_mfma_f32_32x32x16_bf16 v[48:63], v[108:111], a[28:31], v[48:63]
    ds_read_b64_tr_b16 v[100:101], v237 offset:20480
    ds_read_b64_tr_b16 v[102:103], v237 offset:20992
    buffer_load_dwordx4 v202, s[4:7], s44 offen offset:2048 lds
    s_waitcnt lgkmcnt(12)
    v_mfma_f32_32x32x16_bf16 v[32:47], v[80:83], a[32:35], v[32:47]
    ds_read_b128 a[44:47], v211 offset:32768
    ds_read_b64_tr_b16 v[104:105], v212 offset:22528
    ds_read_b64_tr_b16 v[106:107], v212 offset:23040
    buffer_load_dwordx4 v203, s[4:7], s44 offen offset:3072 lds
    s_waitcnt lgkmcnt(13)
    v_mfma_f32_32x32x16_bf16 v[48:63], v[84:87], a[32:35], v[48:63]
    ds_read_b64_tr_b16 v[108:109], v237 offset:22528
    ds_read_b64_tr_b16 v[110:111], v237 offset:23040
    s_waitcnt lgkmcnt(12)
    v_mfma_f32_32x32x16_bf16 v[32:47], v[88:91], a[36:39], v[32:47]
    s_waitcnt vmcnt(7)
    s_barrier
    ds_read_b128 a[48:51], v208 offset:49152
    ds_read_b64_tr_b16 v[80:81], v212 offset:24576
    ds_read_b64_tr_b16 v[82:83], v212 offset:25088
    s_add_u32 m0, s3, 8192
    s_waitcnt lgkmcnt(13)
    v_mfma_f32_32x32x16_bf16 v[48:63], v[92:95], a[36:39], v[48:63]
    ds_read_b64_tr_b16 v[84:85], v237 offset:24576
    ds_read_b64_tr_b16 v[86:87], v237 offset:25088
    buffer_load_dwordx4 v204, s[8:11], s55 offen offset:0 lds
    s_waitcnt lgkmcnt(12)
    v_mfma_f32_32x32x16_bf16 v[32:47], v[96:99], a[40:43], v[32:47]
    ds_read_b128 a[52:55], v209 offset:49152
    ds_read_b64_tr_b16 v[88:89], v212 offset:26624
    ds_read_b64_tr_b16 v[90:91], v212 offset:27136
    buffer_load_dwordx4 v205, s[8:11], s55 offen offset:1024 lds
    s_add_u32 m0, s36, 16384
    s_waitcnt lgkmcnt(13)
    v_mfma_f32_32x32x16_bf16 v[48:63], v[100:103], a[40:43], v[48:63]
    ds_read_b64_tr_b16 v[92:93], v237 offset:26624
    ds_read_b64_tr_b16 v[94:95], v237 offset:27136
    buffer_load_dwordx4 v200, s[4:7], s45 offen offset:0 lds
    s_waitcnt lgkmcnt(12)
    v_mfma_f32_32x32x16_bf16 v[32:47], v[104:107], a[44:47], v[32:47]
    ds_read_b128 a[56:59], v210 offset:49152
    ds_read_b64_tr_b16 v[96:97], v212 offset:28672
    ds_read_b64_tr_b16 v[98:99], v212 offset:29184
    buffer_load_dwordx4 v201, s[4:7], s45 offen offset:1024 lds
    s_waitcnt lgkmcnt(13)
    v_mfma_f32_32x32x16_bf16 v[48:63], v[108:111], a[44:47], v[48:63]
    ds_read_b64_tr_b16 v[100:101], v237 offset:28672
    ds_read_b64_tr_b16 v[102:103], v237 offset:29184
    buffer_load_dwordx4 v202, s[4:7], s45 offen offset:2048 lds
    s_waitcnt lgkmcnt(12)
    v_mfma_f32_32x32x16_bf16 v[32:47], v[80:83], a[48:51], v[32:47]
    ds_read_b128 a[60:63], v211 offset:49152
    ds_read_b64_tr_b16 v[104:105], v212 offset:30720
    ds_read_b64_tr_b16 v[106:107], v212 offset:31232
    buffer_load_dwordx4 v203, s[4:7], s45 offen offset:3072 lds
    s_waitcnt lgkmcnt(13)
    v_mfma_f32_32x32x16_bf16 v[48:63], v[84:87], a[48:51], v[48:63]
    ds_read_b64_tr_b16 v[108:109], v237 offset:30720
    ds_read_b64_tr_b16 v[110:111], v237 offset:31232
    s_waitcnt lgkmcnt(12)
    v_mfma_f32_32x32x16_bf16 v[32:47], v[88:91], a[52:55], v[32:47]
    s_waitcnt vmcnt(6)
    s_barrier
    ds_read_b128 a[64:67], v208 offset:0
    ds_read_b64_tr_b16 v[80:81], v212 offset:0
    ds_read_b64_tr_b16 v[82:83], v212 offset:512
    s_add_u32 m0, s3, 16384
    s_waitcnt lgkmcnt(13)
    v_mfma_f32_32x32x16_bf16 v[48:63], v[92:95], a[52:55], v[48:63]
    ds_read_b64_tr_b16 v[84:85], v237 offset:0
    ds_read_b64_tr_b16 v[86:87], v237 offset:512
    buffer_load_dwordx4 v204, s[8:11], s56 offen offset:0 lds
    s_waitcnt lgkmcnt(12)
    v_mfma_f32_32x32x16_bf16 v[32:47], v[96:99], a[56:59], v[32:47]
    ds_read_b128 a[68:71], v209 offset:0
    ds_read_b64_tr_b16 v[88:89], v212 offset:2048
    ds_read_b64_tr_b16 v[90:91], v212 offset:2560
    buffer_load_dwordx4 v205, s[8:11], s56 offen offset:1024 lds
    s_add_u32 m0, s36, 32768
    s_waitcnt lgkmcnt(13)
    v_mfma_f32_32x32x16_bf16 v[48:63], v[100:103], a[56:59], v[48:63]
    ds_read_b64_tr_b16 v[92:93], v237 offset:2048
    ds_read_b64_tr_b16 v[94:95], v237 offset:2560
    buffer_load_dwordx4 v200, s[4:7], s46 offen offset:0 lds
    s_waitcnt lgkmcnt(12)
    v_mfma_f32_32x32x16_bf16 v[32:47], v[104:107], a[60:63], v[32:47]
    ds_read_b128 a[72:75], v210 offset:0
    ds_read_b64_tr_b16 v[96:97], v212 offset:4096
    ds_read_b64_tr_b16 v[98:99], v212 offset:4608
    buffer_load_dwordx4 v201, s[4:7], s46 offen offset:1024 lds
    s_waitcnt lgkmcnt(13)
    v_mfma_f32_32x32x16_bf16 v[48:63], v[108:111], a[60:63], v[48:63]
    ds_read_b64_tr_b16 v[100:101], v237 offset:4096
    ds_read_b64_tr_b16 v[102:103], v237 offset:4608
    buffer_load_dwordx4 v202, s[4:7], s46 offen offset:2048 lds
    s_waitcnt lgkmcnt(12)
    v_mfma_f32_32x32x16_bf16 v[32:47], v[80:83], a[64:67], v[32:47]
    ds_read_b128 a[76:79], v211 offset:0
    ds_read_b64_tr_b16 v[104:105], v212 offset:6144
    ds_read_b64_tr_b16 v[106:107], v212 offset:6656
    buffer_load_dwordx4 v203, s[4:7], s46 offen offset:3072 lds
    s_waitcnt lgkmcnt(13)
    v_mfma_f32_32x32x16_bf16 v[48:63], v[84:87], a[64:67], v[48:63]
    ds_read_b64_tr_b16 v[108:109], v237 offset:6144
    ds_read_b64_tr_b16 v[110:111], v237 offset:6656
    s_waitcnt lgkmcnt(12)
    v_mfma_f32_32x32x16_bf16 v[32:47], v[88:91], a[68:71], v[32:47]
    s_waitcnt vmcnt(6)
    s_barrier
    ds_read_b128 a[80:83], v208 offset:16384
    ds_read_b64_tr_b16 v[80:81], v212 offset:8192
    ds_read_b64_tr_b16 v[82:83], v212 offset:8704
    s_add_u32 m0, s3, 24576
    s_waitcnt lgkmcnt(13)
    v_mfma_f32_32x32x16_bf16 v[48:63], v[92:95], a[68:71], v[48:63]
    ds_read_b64_tr_b16 v[84:85], v237 offset:8192
    ds_read_b64_tr_b16 v[86:87], v237 offset:8704
    buffer_load_dwordx4 v204, s[8:11], s57 offen offset:0 lds
    s_waitcnt lgkmcnt(12)
    v_mfma_f32_32x32x16_bf16 v[32:47], v[96:99], a[72:75], v[32:47]
    ds_read_b128 a[84:87], v209 offset:16384
    ds_read_b64_tr_b16 v[88:89], v212 offset:10240
    ds_read_b64_tr_b16 v[90:91], v212 offset:10752
    buffer_load_dwordx4 v205, s[8:11], s57 offen offset:1024 lds
    s_add_u32 m0, s36, 49152
    s_waitcnt lgkmcnt(13)
    v_mfma_f32_32x32x16_bf16 v[48:63], v[100:103], a[72:75], v[48:63]
    ds_read_b64_tr_b16 v[92:93], v237 offset:10240
    ds_read_b64_tr_b16 v[94:95], v237 offset:10752
    buffer_load_dwordx4 v200, s[4:7], s47 offen offset:0 lds
    s_waitcnt lgkmcnt(12)
    v_mfma_f32_32x32x16_bf16 v[32:47], v[104:107], a[76:79], v[32:47]
    ds_read_b128 a[88:91], v210 offset:16384
    ds_read_b64_tr_b16 v[96:97], v212 offset:12288
    ds_read_b64_tr_b16 v[98:99], v212 offset:12800
    buffer_load_dwordx4 v201, s[4:7], s47 offen offset:1024 lds
    s_waitcnt lgkmcnt(13)
    v_mfma_f32_32x32x16_bf16 v[48:63], v[108:111], a[76:79], v[48:63]
    ds_read_b64_tr_b16 v[100:101], v237 offset:12288
    ds_read_b64_tr_b16 v[102:103], v237 offset:12800
    buffer_load_dwordx4 v202, s[4:7], s47 offen offset:2048 lds
    s_waitcnt lgkmcnt(12)
    v_mfma_f32_32x32x16_bf16 v[32:47], v[80:83], a[80:83], v[32:47]
    ds_read_b128 a[92:95], v211 offset:16384
    ds_read_b64_tr_b16 v[104:105], v212 offset:14336
    ds_read_b64_tr_b16 v[106:107], v212 offset:14848
    buffer_load_dwordx4 v203, s[4:7], s47 offen offset:3072 lds
    s_waitcnt lgkmcnt(13)
    v_mfma_f32_32x32x16_bf16 v[48:63], v[84:87], a[80:83], v[48:63]
    ds_read_b64_tr_b16 v[108:109], v237 offset:14336
    ds_read_b64_tr_b16 v[110:111], v237 offset:14848
    s_waitcnt lgkmcnt(12)
    v_mfma_f32_32x32x16_bf16 v[32:47], v[88:91], a[84:87], v[32:47]
    s_waitcnt vmcnt(6)
    s_barrier
    ds_read_b128 a[96:99], v208 offset:32768
    ds_read_b64_tr_b16 v[80:81], v212 offset:16384
    ds_read_b64_tr_b16 v[82:83], v212 offset:16896
    s_add_u32 m0, s3, 0
    s_waitcnt lgkmcnt(13)
    v_mfma_f32_32x32x16_bf16 v[48:63], v[92:95], a[84:87], v[48:63]
    ds_read_b64_tr_b16 v[84:85], v237 offset:16384
    ds_read_b64_tr_b16 v[86:87], v237 offset:16896
    buffer_load_dwordx4 v204, s[8:11], s58 offen offset:0 lds
    s_waitcnt lgkmcnt(12)
    v_mfma_f32_32x32x16_bf16 v[32:47], v[96:99], a[88:91], v[32:47]
    ds_read_b128 a[100:103], v209 offset:32768
    ds_read_b64_tr_b16 v[88:89], v212 offset:18432
    ds_read_b64_tr_b16 v[90:91], v212 offset:18944
    buffer_load_dwordx4 v205, s[8:11], s58 offen offset:1024 lds
    s_add_u32 m0, s36, 0
    s_waitcnt lgkmcnt(13)
    v_mfma_f32_32x32x16_bf16 v[48:63], v[100:103], a[88:91], v[48:63]
    ds_read_b64_tr_b16 v[92:93], v237 offset:18432
    ds_read_b64_tr_b16 v[94:95], v237 offset:18944
    buffer_load_dwordx4 v200, s[4:7], s48 offen offset:0 lds
    s_waitcnt lgkmcnt(12)
    v_mfma_f32_32x32x16_bf16 v[32:47], v[104:107], a[92:95], v[32:47]
    ds_read_b128 a[104:107], v210 offset:32768
    ds_read_b64_tr_b16 v[96:97], v212 offset:20480
    ds_read_b64_tr_b16 v[98:99], v212 offset:20992
    buffer_load_dwordx4 v201, s[4:7], s48 offen offset:1024 lds
    s_waitcnt lgkmcnt(13)
    v_mfma_f32_32x32x16_bf16 v[48:63], v[108:111], a[92:95], v[48:63]
    ds_read_b64_tr_b16 v[100:101], v237 offset:20480
    ds_read_b64_tr_b16 v[102:103], v237 offset:20992
    buffer_load_dwordx4 v202, s[4:7], s48 offen offset:2048 lds
    s_waitcnt lgkmcnt(12)
    v_mfma_f32_32x32x16_bf16 v[32:47], v[80:83], a[96:99], v[32:47]
    ds_read_b128 a[108:111], v211 offset:32768
    ds_read_b64_tr_b16 v[104:105], v212 offset:22528
    ds_read_b64_tr_b16 v[106:107], v212 offset:23040
    buffer_load_dwordx4 v203, s[4:7], s48 offen offset:3072 lds
    s_waitcnt lgkmcnt(13)
    v_mfma_f32_32x32x16_bf16 v[48:63], v[84:87], a[96:99], v[48:63]
    ds_read_b64_tr_b16 v[108:109], v237 offset:22528
    ds_read_b64_tr_b16 v[110:111], v237 offset:23040
    s_waitcnt lgkmcnt(12)
    v_mfma_f32_32x32x16_bf16 v[32:47], v[88:91], a[100:103], v[32:47]
    s_waitcnt vmcnt(6)
    s_barrier
    ds_read_b128 a[112:115], v208 offset:49152
    ds_read_b64_tr_b16 v[80:81], v212 offset:24576
    ds_read_b64_tr_b16 v[82:83], v212 offset:25088
    buffer_load_dwordx2 v[20:21], v222, s[24:27], 0 offen sc1
    s_add_u32 m0, s3, 8192
    s_waitcnt lgkmcnt(13)
    v_mfma_f32_32x32x16_bf16 v[48:63], v[92:95], a[100:103], v[48:63]
    ds_read_b64_tr_b16 v[84:85], v237 offset:24576
    ds_read_b64_tr_b16 v[86:87], v237 offset:25088
    buffer_load_dwordx4 v204, s[8:11], s59 offen offset:0 lds
    s_waitcnt lgkmcnt(12)
    v_mfma_f32_32x32x16_bf16 v[32:47], v[96:99], a[104:107], v[32:47]
    ds_read_b128 a[116:119], v209 offset:49152
    ds_read_b64_tr_b16 v[88:89], v212 offset:26624
    ds_read_b64_tr_b16 v[90:91], v212 offset:27136
    buffer_load_dwordx4 v205, s[8:11], s59 offen offset:1024 lds
    s_add_u32 m0, s36, 16384
    s_waitcnt lgkmcnt(13)
    v_mfma_f32_32x32x16_bf16 v[48:63], v[100:103], a[104:107], v[48:63]
    ds_read_b64_tr_b16 v[92:93], v237 offset:26624
    ds_read_b64_tr_b16 v[94:95], v237 offset:27136
    buffer_load_dwordx4 v200, s[4:7], s49 offen offset:0 lds
    s_waitcnt lgkmcnt(12)
    v_mfma_f32_32x32x16_bf16 v[32:47], v[104:107], a[108:111], v[32:47]
    ds_read_b128 a[120:123], v210 offset:49152
    ds_read_b64_tr_b16 v[96:97], v212 offset:28672
    ds_read_b64_tr_b16 v[98:99], v212 offset:29184
    buffer_load_dwordx4 v201, s[4:7], s49 offen offset:1024 lds
    s_waitcnt lgkmcnt(13)
    v_mfma_f32_32x32x16_bf16 v[48:63], v[108:111], a[108:111], v[48:63]
    ds_read_b64_tr_b16 v[100:101], v237 offset:28672
    ds_read_b64_tr_b16 v[102:103], v237 offset:29184
    buffer_load_dwordx4 v202, s[4:7], s49 offen offset:2048 lds
    s_waitcnt lgkmcnt(12)
    v_mfma_f32_32x32x16_bf16 v[32:47], v[80:83], a[112:115], v[32:47]
    ds_read_b128 a[124:127], v211 offset:49152
    ds_read_b64_tr_b16 v[104:105], v212 offset:30720
    ds_read_b64_tr_b16 v[106:107], v212 offset:31232
    buffer_load_dwordx4 v203, s[4:7], s49 offen offset:3072 lds
    s_waitcnt lgkmcnt(13)
    v_mfma_f32_32x32x16_bf16 v[48:63], v[84:87], a[112:115], v[48:63]
    ds_read_b64_tr_b16 v[108:109], v237 offset:30720
    ds_read_b64_tr_b16 v[110:111], v237 offset:31232
    s_waitcnt lgkmcnt(12)
    v_mfma_f32_32x32x16_bf16 v[32:47], v[88:91], a[116:119], v[32:47]
    s_waitcnt vmcnt(7)
    s_mov_b32 s75, 0x40000
    s_waitcnt vmcnt(6)
    s_branch L_pw_chk
L_pw_loop:
    buffer_load_dwordx2 v[20:21], v222, s[24:27], 0 offen sc1
    s_waitcnt vmcnt(0)
L_pw_chk:
    v_cmp_ne_u64 vcc, v[20:21], v[22:23]
    s_sub_u32 s75, s75, 1
    s_cbranch_scc1 L_pw_done
    s_cbranch_vccnz L_pw_loop
L_pw_done:
    s_barrier
    ds_read_b128 a[128:131], v208 offset:0
    ds_read_b64_tr_b16 v[80:81], v212 offset:0
    ds_read_b64_tr_b16 v[82:83], v212 offset:512
    s_add_u32 m0, s73, 0
    s_lshl_b32 s34, s40, 5
    s_add_u32 s34, s34, s37
    s_waitcnt lgkmcnt(13)
    v_mfma_f32_32x32x16_bf16 v[48:63], v[92:95], a[116:119], v[48:63]
    ds_read_b64_tr_b16 v[84:85], v237 offset:0
    ds_read_b64_tr_b16 v[86:87], v237 offset:512
    buffer_load_dwordx4 v6, s[24:27], s34 offen sc1 lds
    s_add_u32 m0, s73, 4096
    s_lshl_b32 s34, s41, 5
    s_add_u32 s34, s34, s37
    s_waitcnt lgkmcnt(12)
    v_mfma_f32_32x32x16_bf16 v[32:47], v[96:99], a[120:123], v[32:47]
    ds_read_b128 a[132:135], v209 offset:0
    ds_read_b64_tr_b16 v[88:89], v212 offset:2048
    ds_read_b64_tr_b16 v[90:91], v212 offset:2560
    buffer_load_dwordx4 v6, s[24:27], s34 offen sc1 lds
    s_add_u32 m0, s73, 8192
    s_lshl_b32 s34, s42, 5
    s_add_u32 s34, s34, s37
    s_waitcnt lgkmcnt(13)
    v_mfma_f32_32x32x16_bf16 v[48:63], v[100:103], a[120:123], v[48:63]
    ds_read_b64_tr_b16 v[92:93], v237 offset:2048
    ds_read_b64_tr_b16 v[94:95], v237 offset:2560
    buffer_load_dwordx4 v6, s[24:27], s34 offen sc1 lds
    s_add_u32 m0, s73, 12288
    s_lshl_b32 s34, s43, 5
    s_add_u32 s34, s34, s37
    s_waitcnt lgkmcnt(12)
    v_mfma_f32_32x32x16_bf16 v[32:47], v[104:107], a[124:127], v[32:47]
    ds_read_b128 a[136:139], v210 offset:0
    ds_read_b64_tr_b16 v[96:97], v212 offset:4096
    ds_read_b64_tr_b16 v[98:99], v212 offset:4608
    buffer_load_dwordx4 v6, s[24:27], s34 offen sc1 lds
    s_add_u32 m0, s73, 16384
    s_lshl_b32 s34, s44, 5
    s_add_u32 s34, s34, s37
    s_waitcnt lgkmcnt(13)
    v_mfma_f32_32x32x16_bf16 v[48:63], v[108:111], a[124:127], v[48:63]
    ds_read_b64_tr_b16 v[100:101], v237 offset:4096
    ds_read_b64_tr_b16 v[102:103], v237 offset:4608
    buffer_load_dwordx4 v6, s[24:27], s34 offen sc1 lds
    s_add_u32 m0, s73, 20480
    s_lshl_b32 s34, s45, 5
    s_add_u32 s34, s34, s37
    s_waitcnt lgkmcnt(12)
    v_mfma_f32_32x32x16_bf16 v[32:47], v[80:83], a[128:131], v[32:47]
    ds_read_b128 a[140:143], v211 offset:0
    ds_read_b64_tr_b16 v[104:105], v212 offset:6144
    ds_read_b64_tr_b16 v[106:107], v212 offset:6656
    buffer_load_dwordx4 v6, s[24:27], s34 offen sc1 lds
    s_add_u32 m0, s73, 24576
    s_lshl_b32 s34, s46, 5
    s_add_u32 s34, s34, s37
    s_waitcnt lgkmcnt(13)
    v_mfma_f32_32x32x16_bf16 v[48:63], v[84:87], a[128:131], v[48:63]
    ds_read_b64_tr_b16 v[108:109], v237 offset:6144
    ds_read_b64_tr_b16 v[110:111], v237 offset:6656
    buffer_load_dwordx4 v6, s[24:27], s34 offen sc1 lds
    s_waitcnt lgkmcnt(12)
    v_mfma_f32_32x32x16_bf16 v[32:47], v[88:91], a[132:135], v[32:47]
    s_waitcnt vmcnt(7)
    s_barrier
    ds_read_b128 a[144:147], v208 offset:16384
    ds_read_b64_tr_b16 v[80:81], v212 offset:8192
    ds_read_b64_tr_b16 v[82:83], v212 offset:8704
    s_add_u32 m0, s73, 28672
    s_lshl_b32 s34, s47, 5
    s_add_u32 s34, s34, s37
    s_waitcnt lgkmcnt(13)
    v_mfma_f32_32x32x16_bf16 v[48:63], v[92:95], a[132:135], v[48:63]
    ds_read_b64_tr_b16 v[84:85], v237 offset:8192
    ds_read_b64_tr_b16 v[86:87], v237 offset:8704
    buffer_load_dwordx4 v6, s[24:27], s34 offen sc1 lds
    s_add_u32 m0, s73, 32768
    s_lshl_b32 s34, s48, 5
    s_add_u32 s34, s34, s37
    s_waitcnt lgkmcnt(12)
    v_mfma_f32_32x32x16_bf16 v[32:47], v[96:99], a[136:139], v[32:47]
    ds_read_b128 a[148:151], v209 offset:16384
    ds_read_b64_tr_b16 v[88:89], v212 offset:10240
    ds_read_b64_tr_b16 v[90:91], v212 offset:10752
    buffer_load_dwordx4 v6, s[24:27], s34 offen sc1 lds
    s_add_u32 m0, s73, 36864
    s_lshl_b32 s34, s49, 5
    s_add_u32 s34, s34, s37
    s_waitcnt lgkmcnt(13)
    v_mfma_f32_32x32x16_bf16 v[48:63], v[100:103], a[136:139], v[48:63]
    ds_read_b64_tr_b16 v[92:93], v237 offset:10240
    ds_read_b64_tr_b16 v[94:95], v237 offset:10752
    buffer_load_dwordx4 v6, s[24:27], s34 offen sc1 lds
    s_waitcnt lgkmcnt(12)
    v_mfma_f32_32x32x16_bf16 v[32:47], v[104:107], a[140:143], v[32:47]
    ds_read_b128 a[152:155], v210 offset:16384
    ds_read_b64_tr_b16 v[96:97], v212 offset:12288
    ds_read_b64_tr_b16 v[98:99], v212 offset:12800
    s_waitcnt lgkmcnt(13)
    v_mfma_f32_32x32x16_bf16 v[48:63], v[108:111], a[140:143], v[48:63]
    ds_read_b64_tr_b16 v[100:101], v237 offset:12288
    ds_read_b64_tr_b16 v[102:103], v237 offset:12800
    s_waitcnt lgkmcnt(12)
    v_mfma_f32_32x32x16_bf16 v[32:47], v[80:83], a[144:147], v[32:47]
    ds_read_b128 a[156:159], v211 offset:16384
    ds_read_b64_tr_b16 v[104:105], v212 offset:14336
    ds_read_b64_tr_b16 v[106:107], v212 offset:14848
    s_waitcnt lgkmcnt(13)
    v_mfma_f32_32x32x16_bf16 v[48:63], v[84:87], a[144:147], v[48:63]
    ds_read_b64_tr_b16 v[108:109], v237 offset:14336
    ds_read_b64_tr_b16 v[110:111], v237 offset:14848
    s_waitcnt lgkmcnt(12)
    v_mfma_f32_32x32x16_bf16 v[32:47], v[88:91], a[148:151], v[32:47]
    s_waitcnt lgkmcnt(10)
    v_mfma_f32_32x32x16_bf16 v[48:63], v[92:95], a[148:151], v[48:63]
    s_waitcnt lgkmcnt(7)
    v_mfma_f32_32x32x16_bf16 v[32:47], v[96:99], a[152:155], v[32:47]
    s_waitcnt lgkmcnt(5)
    v_mfma_f32_32x32x16_bf16 v[48:63], v[100:103], a[152:155], v[48:63]
    s_waitcnt lgkmcnt(2)
    v_mfma_f32_32x32x16_bf16 v[32:47], v[104:107], a[156:159], v[32:47]
    s_waitcnt lgkmcnt(0)
    v_mfma_f32_32x32x16_bf16 v[48:63], v[108:111], a[156:159], v[48:63]
    s_add_u32 s61, s38, 4096
    s_add_u32 m0, s36, 32768
    s_mul_i32 s39, s0, 40960
    s_add_u32 s39, s39, s64
    buffer_load_dwordx4 v10, s[12:15], s39 offen offset:0 lds
    s_nop 1
    v_pk_mul_f32 v[128:129], v[32:33], s[62:63]
    v_pk_mul_f32 v[130:131], v[34:35], s[62:63]
    v_pk_mul_f32 v[132:133], v[36:37], s[62:63]
    v_pk_mul_f32 v[134:135], v[38:39], s[62:63]
    v_exp_f32 v128, v128
    v_exp_f32 v129, v129
    v_exp_f32 v130, v130
    v_exp_f32 v131, v131
    v_exp_f32 v132, v132
    v_exp_f32 v133, v133
    v_exp_f32 v134, v134
    v_exp_f32 v135, v135
    v_pk_add_f32 v[128:129], v[128:129], 1.0 op_sel_hi:[1,0]
    v_pk_add_f32 v[130:131], v[130:131], 1.0 op_sel_hi:[1,0]
    v_pk_add_f32 v[132:133], v[132:133], 1.0 op_sel_hi:[1,0]
    v_pk_add_f32 v[134:135], v[134:135], 1.0 op_sel_hi:[1,0]
    v_rcp_f32 v128, v128
    v_rcp_f32 v129, v129
    v_rcp_f32 v130, v130
    v_rcp_f32 v131, v131
    v_rcp_f32 v132, v132
    v_rcp_f32 v133, v133
    v_rcp_f32 v134, v134
    v_rcp_f32 v135, v135
    buffer_load_dwordx4 v11, s[12:15], s39 offen offset:1024 lds
    v_pk_mul_f32 v[128:129], v[128:129], v[32:33]
    v_pk_mul_f32 v[130:131], v[130:131], v[34:35]
    v_pk_mul_f32 v[132:133], v[132:133], v[36:37]
    v_pk_mul_f32 v[134:135], v[134:135], v[38:39]
    v_cvt_pk_bf16_f32 v144, v128, v129
    v_cvt_pk_bf16_f32 v145, v130, v131
    v_cvt_pk_bf16_f32 v146, v132, v133
    v_cvt_pk_bf16_f32 v147, v134, v135
    buffer_store_dwordx4 v[144:147], v9, s[24:27], s38 offen offset:0 sc1
    v_pk_mul_f32 v[136:137], v[40:41], s[62:63]
    v_pk_mul_f32 v[138:139], v[42:43], s[62:63]
    v_pk_mul_f32 v[140:141], v[44:45], s[62:63]
    v_pk_mul_f32 v[142:143], v[46:47], s[62:63]
    v_exp_f32 v136, v136
    v_exp_f32 v137, v137
    v_exp_f32 v138, v138
    v_exp_f32 v139, v139
    v_exp_f32 v140, v140
    v_exp_f32 v141, v141
    v_exp_f32 v142, v142
    v_exp_f32 v143, v143
    v_pk_add_f32 v[136:137], v[136:137], 1.0 op_sel_hi:[1,0]
    v_pk_add_f32 v[138:139], v[138:139], 1.0 op_sel_hi:[1,0]
    v_pk_add_f32 v[140:141], v[140:141], 1.0 op_sel_hi:[1,0]
    buffer_load_dwordx4 v12, s[12:15], s39 offen offset:2048 lds
    v_pk_add_f32 v[142:143], v[142:143], 1.0 op_sel_hi:[1,0]
    v_rcp_f32 v136, v136
    v_rcp_f32 v137, v137
    v_rcp_f32 v138, v138
    v_rcp_f32 v139, v139
    v_rcp_f32 v140, v140
    v_rcp_f32 v141, v141
    v_rcp_f32 v142, v142
    v_rcp_f32 v143, v143
    v_pk_mul_f32 v[136:137], v[136:137], v[40:41]
    v_pk_mul_f32 v[138:139], v[138:139], v[42:43]
    v_pk_mul_f32 v[140:141], v[140:141], v[44:45]
    v_pk_mul_f32 v[142:143], v[142:143], v[46:47]
    v_cvt_pk_bf16_f32 v148, v136, v137
    v_cvt_pk_bf16_f32 v149, v138, v139
    v_cvt_pk_bf16_f32 v150, v140, v141
    v_cvt_pk_bf16_f32 v151, v142, v143
    buffer_store_dwordx4 v[148:151], v9, s[24:27], s38 offen offset:256 sc1
    v_pk_mul_f32 v[128:129], v[48:49], s[62:63]
    v_pk_mul_f32 v[130:131], v[50:51], s[62:63]
    v_pk_mul_f32 v[132:133], v[52:53], s[62:63]
    v_pk_mul_f32 v[134:135], v[54:55], s[62:63]
    v_exp_f32 v128, v128
    v_exp_f32 v129, v129
    buffer_load_dwordx4 v13, s[12:15], s39 offen offset:3072 lds
    v_exp_f32 v130, v130
    v_exp_f32 v131, v131
    v_exp_f32 v132, v132
    v_exp_f32 v133, v133
    v_exp_f32 v134, v134
    v_exp_f32 v135, v135
    v_pk_add_f32 v[128:129], v[128:129], 1.0 op_sel_hi:[1,0]
    v_pk_add_f32 v[130:131], v[130:131], 1.0 op_sel_hi:[1,0]
    v_pk_add_f32 v[132:133], v[132:133], 1.0 op_sel_hi:[1,0]
    v_pk_add_f32 v[134:135], v[134:135], 1.0 op_sel_hi:[1,0]
    v_rcp_f32 v128, v128
    v_rcp_f32 v129, v129
    v_rcp_f32 v130, v130
    v_rcp_f32 v131, v131
    v_rcp_f32 v132, v132
    v_rcp_f32 v133, v133
    v_rcp_f32 v134, v134
    v_rcp_f32 v135, v135
    v_pk_mul_f32 v[128:129], v[128:129], v[48:49]
    v_pk_mul_f32 v[130:131], v[130:131], v[50:51]
    v_pk_mul_f32 v[132:133], v[132:133], v[52:53]
    v_pk_mul_f32 v[134:135], v[134:135], v[54:55]
    v_cvt_pk_bf16_f32 v152, v128, v129
    v_cvt_pk_bf16_f32 v153, v130, v131
    s_add_u32 m0, s73, 40960
    s_lshl_b32 s39, s0, 10
    s_add_u32 s39, s39, s65
    buffer_load_dwordx4 v6, s[24:27], s39 offen sc1 lds
    v_cvt_pk_bf16_f32 v154, v132, v133
    v_cvt_pk_bf16_f32 v155, v134, v135
    buffer_store_dwordx4 v[152:155], v9, s[24:27], s38 offen offset:2048 sc1
    v_pk_mul_f32 v[136:137], v[56:57], s[62:63]
    v_pk_mul_f32 v[138:139], v[58:59], s[62:63]
    v_pk_mul_f32 v[140:141], v[60:61], s[62:63]
    v_pk_mul_f32 v[142:143], v[62:63], s[62:63]
    v_exp_f32 v136, v136
    v_exp_f32 v137, v137
    v_exp_f32 v138, v138
    v_exp_f32 v139, v139
    v_exp_f32 v140, v140
    v_exp_f32 v141, v141
    v_exp_f32 v142, v142
    v_exp_f32 v143, v143
    v_pk_add_f32 v[136:137], v[136:137], 1.0 op_sel_hi:[1,0]
    v_pk_add_f32 v[138:139], v[138:139], 1.0 op_sel_hi:[1,0]
    v_pk_add_f32 v[140:141], v[140:141], 1.0 op_sel_hi:[1,0]
    v_pk_add_f32 v[142:143], v[142:143], 1.0 op_sel_hi:[1,0]
    v_rcp_f32 v136, v136
    v_rcp_f32 v137, v137
    v_rcp_f32 v138, v138
    v_rcp_f32 v139, v139
    v_rcp_f32 v140, v140
    v_rcp_f32 v141, v141
    s_waitcnt vmcnt(14)
    s_barrier
    v_rcp_f32 v142, v142
    ds_read_b64_tr_b16 v[112:113], v17 offset:0
    ds_read_b64_tr_b16 v[114:115], v17 offset:256
    v_rcp_f32 v143, v143
    v_pk_mul_f32 v[136:137], v[136:137], v[56:57]
    ds_read_b64_tr_b16 v[116:117], v17 offset:1024
    ds_read_b64_tr_b16 v[118:119], v17 offset:1280
    v_pk_mul_f32 v[138:139], v[138:139], v[58:59]
    v_pk_mul_f32 v[140:141], v[140:141], v[60:61]
    ds_read_b64_tr_b16 v[120:121], v17 offset:2048
    ds_read_b64_tr_b16 v[122:123], v17 offset:2304
    v_pk_mul_f32 v[142:143], v[142:143], v[62:63]
    v_cvt_pk_bf16_f32 v156, v136, v137
    ds_read_b64_tr_b16 v[124:125], v17 offset:3072
    ds_read_b64_tr_b16 v[126:127], v17 offset:3328
    v_cvt_pk_bf16_f32 v157, v138, v139
    v_cvt_pk_bf16_f32 v158, v140, v141
    ds_read_b64_tr_b16 v[80:81], v17 offset:4096
    ds_read_b64_tr_b16 v[82:83], v17 offset:4352
    v_cvt_pk_bf16_f32 v159, v142, v143
    buffer_store_dwordx4 v[156:159], v9, s[24:27], s38 offen offset:2304 sc1
    s_waitcnt lgkmcnt(6)
    v_mfma_f32_32x32x16_bf16 v[64:79], v[112:115], a[0:3], 0
    ds_read_b64_tr_b16 v[84:85], v17 offset:5120
    ds_read_b64_tr_b16 v[86:87], v17 offset:5376
    v_mfma_f32_32x32x16_bf16 v[64:79], v[116:119], a[4:7], v[64:79]
    ds_read_b64_tr_b16 v[88:89], v17 offset:6144
    ds_read_b64_tr_b16 v[90:91], v17 offset:6400
    s_add_u32 m0, s36, 49152
    s_mul_i32 s39, s1, 40960
    s_add_u32 s39, s39, s64
    buffer_load_dwordx4 v10, s[12:15], s39 offen offset:0 lds
    s_waitcnt lgkmcnt(6)
    v_mfma_f32_32x32x16_bf16 v[64:79], v[120:123], a[8:11], v[64:79]
    ds_read_b64_tr_b16 v[92:93], v17 offset:7168
    ds_read_b64_tr_b16 v[94:95], v17 offset:7424
    v_mfma_f32_32x32x16_bf16 v[64:79], v[124:127], a[12:15], v[64:79]
    ds_read_b64_tr_b16 v[96:97], v17 offset:8192
    ds_read_b64_tr_b16 v[98:99], v17 offset:8448
    buffer_load_dwordx4 v11, s[12:15], s39 offen offset:1024 lds
    s_waitcnt lgkmcnt(6)
    v_mfma_f32_32x32x16_bf16 v[64:79], v[80:83], a[16:19], v[64:79]
    ds_read_b64_tr_b16 v[100:101], v17 offset:9216
    ds_read_b64_tr_b16 v[102:103], v17 offset:9472
    v_mfma_f32_32x32x16_bf16 v[64:79], v[84:87], a[20:23], v[64:79]
    ds_read_b64_tr_b16 v[104:105], v17 offset:10240
    ds_read_b64_tr_b16 v[106:107], v17 offset:10496
    buffer_load_dwordx4 v12, s[12:15], s39 offen offset:2048 lds
    s_waitcnt lgkmcnt(6)
    v_mfma_f32_32x32x16_bf16 v[64:79], v[88:91], a[24:27], v[64:79]
    ds_read_b64_tr_b16 v[108:109], v17 offset:11264
    ds_read_b64_tr_b16 v[110:111], v17 offset:11520
    v_mfma_f32_32x32x16_bf16 v[64:79], v[92:95], a[28:31], v[64:79]
    ds_read_b64_tr_b16 v[112:113], v17 offset:12288
    ds_read_b64_tr_b16 v[114:115], v17 offset:12544
    buffer_load_dwordx4 v13, s[12:15], s39 offen offset:3072 lds
    s_waitcnt lgkmcnt(6)
    v_mfma_f32_32x32x16_bf16 v[64:79], v[96:99], a[32:35], v[64:79]
    ds_read_b64_tr_b16 v[116:117], v17 offset:13312
    ds_read_b64_tr_b16 v[118:119], v17 offset:13568
    v_mfma_f32_32x32x16_bf16 v[64:79], v[100:103], a[36:39], v[64:79]
    ds_read_b64_tr_b16 v[120:121], v17 offset:14336
    ds_read_b64_tr_b16 v[122:123], v17 offset:14592
    s_add_u32 m0, s73, 45056
    s_lshl_b32 s39, s1, 10
    s_add_u32 s39, s39, s65
    buffer_load_dwordx4 v6, s[24:27], s39 offen sc1 lds
    s_waitcnt lgkmcnt(6)
    v_mfma_f32_32x32x16_bf16 v[64:79], v[104:107], a[40:43], v[64:79]
    ds_read_b64_tr_b16 v[124:125], v17 offset:15360
    ds_read_b64_tr_b16 v[126:127], v17 offset:15616
    v_mfma_f32_32x32x16_bf16 v[64:79], v[108:111], a[44:47], v[64:79]
    s_waitcnt vmcnt(17)
    s_barrier
    ds_read_b64_tr_b16 v[80:81], v17 offset:16384
    ds_read_b64_tr_b16 v[82:83], v17 offset:16640
    s_add_u32 s0, s0, 6
    s_sub_u32 s39, s0, 24
    s_min_u32 s0, s0, s39
    s_add_u32 m0, s36, 81920
    s_mul_i32 s39, s0, 40960
    s_add_u32 s39, s39, s64
    buffer_load_dwordx4 v10, s[12:15], s39 offen offset:0 lds
    s_waitcnt lgkmcnt(6)
    v_mfma_f32_32x32x16_bf16 v[64:79], v[112:115], a[48:51], v[64:79]
    ds_read_b64_tr_b16 v[84:85], v17 offset:17408
    ds_read_b64_tr_b16 v[86:87], v17 offset:17664
    v_mfma_f32_32x32x16_bf16 v[64:79], v[116:119], a[52:55], v[64:79]
    ds_read_b64_tr_b16 v[88:89], v17 offset:18432
    ds_read_b64_tr_b16 v[90:91], v17 offset:18688
    buffer_load_dwordx4 v11, s[12:15], s39 offen offset:1024 lds
    s_waitcnt lgkmcnt(6)
    v_mfma_f32_32x32x16_bf16 v[64:79], v[120:123], a[56:59], v[64:79]
    ds_read_b64_tr_b16 v[92:93], v17 offset:19456
    ds_read_b64_tr_b16 v[94:95], v17 offset:19712
    v_mfma_f32_32x32x16_bf16 v[64:79], v[124:127], a[60:63], v[64:79]
    ds_read_b64_tr_b16 v[96:97], v17 offset:20480
    ds_read_b64_tr_b16 v[98:99], v17 offset:20736
    buffer_load_dwordx4 v12, s[12:15], s39 offen offset:2048 lds
    s_waitcnt lgkmcnt(6)
    v_mfma_f32_32x32x16_bf16 v[64:79], v[80:83], a[64:67], v[64:79]
    ds_read_b64_tr_b16 v[100:101], v17 offset:21504
    ds_read_b64_tr_b16 v[102:103], v17 offset:21760
    s_waitcnt vmcnt(8)
    buffer_store_dwordx2 v[22:23], v224, s[24:27], 0 offen
    buffer_store_dwordx2 v[22:23], v226, s[24:27], s23 offen sc1
    v_mfma_f32_32x32x16_bf16 v[64:79], v[84:87], a[68:71], v[64:79]
    ds_read_b64_tr_b16 v[104:105], v17 offset:22528
    ds_read_b64_tr_b16 v[106:107], v17 offset:22784
    buffer_load_dwordx4 v13, s[12:15], s39 offen offset:3072 lds
    s_waitcnt lgkmcnt(6)
    v_mfma_f32_32x32x16_bf16 v[64:79], v[88:91], a[72:75], v[64:79]
    ds_read_b64_tr_b16 v[108:109], v17 offset:23552
    ds_read_b64_tr_b16 v[110:111], v17 offset:23808
    v_mfma_f32_32x32x16_bf16 v[64:79], v[92:95], a[76:79], v[64:79]
    ds_read_b64_tr_b16 v[112:113], v17 offset:24576
    ds_read_b64_tr_b16 v[114:115], v17 offset:24832
    s_add_u32 m0, s73, 49152
    s_lshl_b32 s39, s0, 10
    s_add_u32 s39, s39, s65
    buffer_load_dwordx4 v6, s[24:27], s39 offen sc1 lds
    s_waitcnt lgkmcnt(6)
    v_mfma_f32_32x32x16_bf16 v[64:79], v[96:99], a[80:83], v[64:79]
    ds_read_b64_tr_b16 v[116:117], v17 offset:25600
    ds_read_b64_tr_b16 v[118:119], v17 offset:25856
    v_mfma_f32_32x32x16_bf16 v[64:79], v[100:103], a[84:87], v[64:79]
    ds_read_b64_tr_b16 v[120:121], v17 offset:26624
    ds_read_b64_tr_b16 v[122:123], v17 offset:26880
    s_add_u32 s0, s0, 6
    s_sub_u32 s39, s0, 24
    s_min_u32 s0, s0, s39
    s_add_u32 m0, s36, 0
    s_mul_i32 s39, s0, 40960
    s_add_u32 s39, s39, s64
    buffer_load_dwordx4 v10, s[12:15], s39 offen offset:0 lds
    s_waitcnt lgkmcnt(6)
    v_mfma_f32_32x32x16_bf16 v[64:79], v[104:107], a[88:91], v[64:79]
    ds_read_b64_tr_b16 v[124:125], v17 offset:27648
    ds_read_b64_tr_b16 v[126:127], v17 offset:27904
    v_mfma_f32_32x32x16_bf16 v[64:79], v[108:111], a[92:95], v[64:79]
    s_barrier
    ds_read_b64_tr_b16 v[80:81], v17 offset:28672
    ds_read_b64_tr_b16 v[82:83], v17 offset:28928
    buffer_load_dwordx4 v11, s[12:15], s39 offen offset:1024 lds
    s_waitcnt lgkmcnt(6)
    v_mfma_f32_32x32x16_bf16 v[64:79], v[112:115], a[96:99], v[64:79]
    ds_read_b64_tr_b16 v[84:85], v17 offset:29696
    ds_read_b64_tr_b16 v[86:87], v17 offset:29952
    v_mfma_f32_32x32x16_bf16 v[64:79], v[116:119], a[100:103], v[64:79]
    ds_read_b64_tr_b16 v[88:89], v17 offset:30720
    ds_read_b64_tr_b16 v[90:91], v17 offset:30976
    buffer_load_dwordx4 v12, s[12:15], s39 offen offset:2048 lds
    s_waitcnt lgkmcnt(6)
    v_mfma_f32_32x32x16_bf16 v[64:79], v[120:123], a[104:107], v[64:79]
    ds_read_b64_tr_b16 v[92:93], v17 offset:31744
    ds_read_b64_tr_b16 v[94:95], v17 offset:32000
    v_mfma_f32_32x32x16_bf16 v[64:79], v[124:127], a[108:111], v[64:79]
    ds_read_b64_tr_b16 v[96:97], v17 offset:32768
    ds_read_b64_tr_b16 v[98:99], v17 offset:33024
    buffer_load_dwordx4 v13, s[12:15], s39 offen offset:3072 lds
    s_waitcnt lgkmcnt(6)
    v_mfma_f32_32x32x16_bf16 v[64:79], v[80:83], a[112:115], v[64:79]
    ds_read_b64_tr_b16 v[100:101], v17 offset:33792
    ds_read_b64_tr_b16 v[102:103], v17 offset:34048
    v_mfma_f32_32x32x16_bf16 v[64:79], v[84:87], a[116:119], v[64:79]
    ds_read_b64_tr_b16 v[104:105], v17 offset:34816
    ds_read_b64_tr_b16 v[106:107], v17 offset:35072
    s_add_u32 m0, s73, 53248
    s_lshl_b32 s39, s0, 10
    s_add_u32 s39, s39, s65
    buffer_load_dwordx4 v6, s[24:27], s39 offen sc1 lds
    s_waitcnt lgkmcnt(6)
    v_mfma_f32_32x32x16_bf16 v[64:79], v[88:91], a[120:123], v[64:79]
    ds_read_b64_tr_b16 v[108:109], v17 offset:35840
    ds_read_b64_tr_b16 v[110:111], v17 offset:36096
    v_mfma_f32_32x32x16_bf16 v[64:79], v[92:95], a[124:127], v[64:79]
    ds_read_b64_tr_b16 v[112:113], v17 offset:36864
    ds_read_b64_tr_b16 v[114:115], v17 offset:37120
    s_add_u32 s0, s0, 6
    s_sub_u32 s39, s0, 24
    s_min_u32 s0, s0, s39
    s_add_u32 m0, s36, 16384
    s_mul_i32 s39, s0, 40960
    s_add_u32 s39, s39, s64
    buffer_load_dwordx4 v10, s[12:15], s39 offen offset:0 lds
    s_waitcnt lgkmcnt(6)
    v_mfma_f32_32x32x16_bf16 v[64:79], v[96:99], a[128:131], v[64:79]
    ds_read_b64_tr_b16 v[116:117], v17 offset:37888
    ds_read_b64_tr_b16 v[118:119], v17 offset:38144
    v_mfma_f32_32x32x16_bf16 v[64:79], v[100:103], a[132:135], v[64:79]
    ds_read_b64_tr_b16 v[120:121], v17 offset:38912
    ds_read_b64_tr_b16 v[122:123], v17 offset:39168
    buffer_load_dwordx4 v11, s[12:15], s39 offen offset:1024 lds
    s_waitcnt lgkmcnt(6)
    v_mfma_f32_32x32x16_bf16 v[64:79], v[104:107], a[136:139], v[64:79]
    ds_read_b64_tr_b16 v[124:125], v17 offset:39936
    ds_read_b64_tr_b16 v[126:127], v17 offset:40192
    v_mfma_f32_32x32x16_bf16 v[64:79], v[108:111], a[140:143], v[64:79]
    buffer_load_dwordx4 v12, s[12:15], s39 offen offset:2048 lds
    s_waitcnt lgkmcnt(4)
    v_mfma_f32_32x32x16_bf16 v[64:79], v[112:115], a[144:147], v[64:79]
    s_waitcnt vmcnt(15)
    s_barrier
    v_permlane16_swap_b32 v144, v148
    v_permlane16_swap_b32 v145, v149
    v_permlane16_swap_b32 v146, v150
    v_permlane16_swap_b32 v147, v151
    v_mfma_f32_32x32x16_bf16 v[64:79], v[116:119], a[148:151], v[64:79]
    buffer_load_dwordx4 v13, s[12:15], s39 offen offset:3072 lds
    s_waitcnt lgkmcnt(0)
    v_mfma_f32_32x32x16_bf16 v[64:79], v[120:123], a[152:155], v[64:79]
    v_permlane16_swap_b32 v152, v156
    v_permlane16_swap_b32 v153, v157
    v_permlane16_swap_b32 v154, v158
    v_permlane16_swap_b32 v155, v159
    v_mfma_f32_32x32x16_bf16 v[64:79], v[124:127], a[156:159], v[64:79]
    s_add_u32 m0, s73, 57344
    s_lshl_b32 s39, s0, 10
    s_add_u32 s39, s39, s65
    buffer_load_dwordx4 v6, s[24:27], s39 offen sc1 lds
    ds_read_b64_tr_b16 v[80:81], v228 offset:32768
    ds_read_b64_tr_b16 v[82:83], v228 offset:33792
    ds_read_b64_tr_b16 v[84:85], v229 offset:32768
    ds_read_b64_tr_b16 v[86:87], v229 offset:33792
    ds_read_b64_tr_b16 v[88:89], v230 offset:32768
    ds_read_b64_tr_b16 v[90:91], v230 offset:33792
    ds_read_b64_tr_b16 v[92:93], v231 offset:32768
    ds_read_b64_tr_b16 v[94:95], v231 offset:33792
    s_nop 3
    v_pk_mul_f32 v[128:129], v[64:65], s[62:63]
    v_pk_mul_f32 v[130:131], v[66:67], s[62:63]
    v_pk_mul_f32 v[132:133], v[68:69], s[62:63]
    v_pk_mul_f32 v[134:135], v[70:71], s[62:63]
    ds_read_b64_tr_b16 v[96:97], v236 offset:0
    ds_read_b64_tr_b16 v[98:99], v236 offset:256
    v_exp_f32 v128, v128
    v_exp_f32 v129, v129
    v_exp_f32 v130, v130
    v_exp_f32 v131, v131
    ds_read_b64_tr_b16 v[100:101], v228 offset:36864
    ds_read_b64_tr_b16 v[102:103], v228 offset:37888
    v_exp_f32 v132, v132
    v_exp_f32 v133, v133
    v_exp_f32 v134, v134
    s_add_u32 s1, s1, 12
    s_sub_u32 s39, s1, 24
    s_min_u32 s1, s1, s39
    s_add_u32 m0, s36, 65536
    s_mul_i32 s39, s1, 40960
    s_add_u32 s39, s39, s64
    buffer_load_dwordx4 v10, s[12:15], s39 offen offset:0 lds
    v_exp_f32 v135, v135
    ds_read_b64_tr_b16 v[104:105], v229 offset:36864
    ds_read_b64_tr_b16 v[106:107], v229 offset:37888
    v_pk_add_f32 v[128:129], v[128:129], 1.0 op_sel_hi:[1,0]
    v_pk_add_f32 v[130:131], v[130:131], 1.0 op_sel_hi:[1,0]
    v_pk_add_f32 v[132:133], v[132:133], 1.0 op_sel_hi:[1,0]
    v_pk_add_f32 v[134:135], v[134:135], 1.0 op_sel_hi:[1,0]
    ds_read_b64_tr_b16 a[112:113], v228 offset:53248
    ds_read_b64_tr_b16 a[114:115], v228 offset:54272
    v_rcp_f32 v128, v128
    v_rcp_f32 v129, v129
    v_rcp_f32 v130, v130
    v_rcp_f32 v131, v131
    ds_read_b64_tr_b16 a[116:117], v229 offset:53248
    ds_read_b64_tr_b16 a[118:119], v229 offset:54272
    v_rcp_f32 v132, v132
    v_rcp_f32 v133, v133
    buffer_load_dwordx4 v11, s[12:15], s39 offen offset:1024 lds
    v_rcp_f32 v134, v134
    v_rcp_f32 v135, v135
    ds_read_b64_tr_b16 a[120:121], v228 offset:57344
    ds_read_b64_tr_b16 a[122:123], v228 offset:58368
    v_pk_mul_f32 v[128:129], v[128:129], v[64:65]
    v_pk_mul_f32 v[130:131], v[130:131], v[66:67]
    v_pk_mul_f32 v[132:133], v[132:133], v[68:69]
    v_pk_mul_f32 v[134:135], v[134:135], v[70:71]
    ds_read_b64_tr_b16 a[124:125], v229 offset:57344
    ds_read_b64_tr_b16 a[126:127], v229 offset:58368
    v_cvt_pk_bf16_f32 v160, v128, v129
    v_cvt_pk_bf16_f32 v161, v130, v131
    v_cvt_pk_bf16_f32 v162, v132, v133
    s_buffer_load_dwordx16 s[84:99], s[24:27], s22
    v_cvt_pk_bf16_f32 v163, v134, v135
    ds_read_b64_tr_b16 a[128:129], v228 offset:61440
    ds_read_b64_tr_b16 a[130:131], v228 offset:62464
    buffer_store_dwordx4 v[160:163], v9, s[24:27], s61 offen offset:0 sc1
    buffer_load_dwordx4 v12, s[12:15], s39 offen offset:2048 lds
    v_pk_mul_f32 v[136:137], v[72:73], s[62:63]
    v_pk_mul_f32 v[138:139], v[74:75], s[62:63]
    v_pk_mul_f32 v[140:141], v[76:77], s[62:63]
    ds_read_b64_tr_b16 a[132:133], v229 offset:61440
    ds_read_b64_tr_b16 a[134:135], v229 offset:62464
    v_pk_mul_f32 v[142:143], v[78:79], s[62:63]
    v_exp_f32 v136, v136
    v_exp_f32 v137, v137
    v_exp_f32 v138, v138
    v_exp_f32 v139, v139
    v_exp_f32 v140, v140
    v_exp_f32 v141, v141
    v_exp_f32 v142, v142
    buffer_load_dwordx4 v13, s[12:15], s39 offen offset:3072 lds
    v_exp_f32 v143, v143
    v_pk_add_f32 v[136:137], v[136:137], 1.0 op_sel_hi:[1,0]
    v_pk_add_f32 v[138:139], v[138:139], 1.0 op_sel_hi:[1,0]
    v_pk_add_f32 v[140:141], v[140:141], 1.0 op_sel_hi:[1,0]
    v_pk_add_f32 v[142:143], v[142:143], 1.0 op_sel_hi:[1,0]
    v_rcp_f32 v136, v136
    v_rcp_f32 v137, v137
    v_rcp_f32 v138, v138
    v_rcp_f32 v139, v139
    v_rcp_f32 v140, v140
    v_rcp_f32 v141, v141
    s_add_u32 m0, s73, 61440
    s_lshl_b32 s39, s1, 10
    s_add_u32 s39, s39, s65
    buffer_load_dwordx4 v6, s[24:27], s39 offen sc1 lds
    v_rcp_f32 v142, v142
    v_rcp_f32 v143, v143
    v_pk_mul_f32 v[136:137], v[136:137], v[72:73]
    v_pk_mul_f32 v[138:139], v[138:139], v[74:75]
    v_pk_mul_f32 v[140:141], v[140:141], v[76:77]
    v_pk_mul_f32 v[142:143], v[142:143], v[78:79]
    v_cvt_pk_bf16_f32 v164, v136, v137
    v_cvt_pk_bf16_f32 v165, v138, v139
    v_cvt_pk_bf16_f32 v166, v140, v141
    v_cvt_pk_bf16_f32 v167, v142, v143
    buffer_store_dwordx4 v[164:167], v9, s[24:27], s61 offen offset:256 sc1
    s_waitcnt lgkmcnt(15)
    v_mfma_f32_16x16x32_bf16 v[24:27], v[80:83], v[144:147], 0
    s_waitcnt lgkmcnt(0)
    s_xor_b64 s[86:87], s[86:87], s[20:21]
    s_xor_b64 s[88:89], s[88:89], s[20:21]
    s_xor_b64 s[90:91], s[90:91], s[20:21]
    s_xor_b64 s[92:93], s[92:93], s[20:21]
    s_xor_b64 s[94:95], s[94:95], s[20:21]
    s_xor_b64 s[96:97], s[96:97], s[20:21]
    s_xor_b64 s[98:99], s[98:99], s[20:21]
    s_or_b64 s[86:87], s[86:87], s[88:89]
    s_or_b64 s[86:87], s[86:87], s[90:91]
    s_or_b64 s[86:87], s[86:87], s[92:93]
    s_or_b64 s[86:87], s[86:87], s[94:95]
    s_or_b64 s[86:87], s[86:87], s[96:97]
    s_or_b64 s[86:87], s[86:87], s[98:99]
    s_cbranch_scc1 L_pr
L_pb:
    ds_read_b64_tr_b16 v[108:109], v230 offset:36864
    ds_read_b64_tr_b16 v[110:111], v230 offset:37888
    v_mfma_f32_16x16x32_bf16 v[44:47], v[80:83], v[148:151], 0
    v_mfma_f32_16x16x32_bf16 v[28:31], v[84:87], v[144:147], 0
    ds_read_b64_tr_b16 v[112:113], v231 offset:36864
    ds_read_b64_tr_b16 v[114:115], v231 offset:37888
    v_mfma_f32_16x16x32_bf16 v[48:51], v[84:87], v[148:151], 0
    buffer_load_dwordx4 a[168:171], v6, s[24:27], s68 offen offset:0 sc1
    v_mfma_f32_16x16x32_bf16 v[32:35], v[88:91], v[144:147], 0
    v_permlane16_swap_b32 v160, v164
    v_permlane16_swap_b32 v161, v165
    v_permlane16_swap_b32 v162, v166
    v_permlane16_swap_b32 v163, v167
    ds_read_b64_tr_b16 v[116:117], v236 offset:1024
    ds_read_b64_tr_b16 v[118:119], v236 offset:1280
    v_mfma_f32_16x16x32_bf16 v[52:55], v[88:91], v[148:151], 0
    v_mfma_f32_16x16x32_bf16 v[36:39], v[92:95], v[144:147], 0
    ds_read_b64_tr_b16 v[120:121], v228 offset:49152
    ds_read_b64_tr_b16 v[122:123], v228 offset:50176
    buffer_load_dwordx4 a[172:175], v6, s[24:27], s68 offen offset:1024 sc1
    v_mfma_f32_16x16x32_bf16 v[56:59], v[92:95], v[148:151], 0
    v_mfma_f32_16x16x32_bf16 v[40:43], v[96:99], v[144:147], 0
    ds_read_b64_tr_b16 v[124:125], v229 offset:49152
    ds_read_b64_tr_b16 v[126:127], v229 offset:50176
    v_mfma_f32_16x16x32_bf16 v[60:63], v[96:99], v[148:151], 0
    buffer_load_dwordx4 a[176:179], v6, s[24:27], s68 offen offset:2048 sc1
    v_mfma_f32_16x16x32_bf16 v[24:27], v[100:103], v[152:155], v[24:27]
    ds_read_b64_tr_b16 v[80:81], v230 offset:49152
    ds_read_b64_tr_b16 v[82:83], v230 offset:50176
    v_mfma_f32_16x16x32_bf16 v[44:47], v[100:103], v[156:159], v[44:47]
    v_mfma_f32_16x16x32_bf16 v[28:31], v[104:107], v[152:155], v[28:31]
    ds_read_b64_tr_b16 v[84:85], v231 offset:49152
    ds_read_b64_tr_b16 v[86:87], v231 offset:50176
    v_mfma_f32_16x16x32_bf16 v[48:51], v[104:107], v[156:159], v[48:51]
    buffer_load_dwordx4 a[180:183], v6, s[24:27], s68 offen offset:3072 sc1
    s_waitcnt lgkmcnt(12)
    v_mfma_f32_16x16x32_bf16 v[32:35], v[108:111], v[152:155], v[32:35]
    ds_read_b64_tr_b16 v[88:89], v236 offset:4096
    ds_read_b64_tr_b16 v[90:91], v236 offset:4352
    v_mfma_f32_16x16x32_bf16 v[52:55], v[108:111], v[156:159], v[52:55]
    s_waitcnt lgkmcnt(12)
    v_mfma_f32_16x16x32_bf16 v[36:39], v[112:115], v[152:155], v[36:39]
    ds_read_b64_tr_b16 v[92:93], v228 offset:40960
    ds_read_b64_tr_b16 v[94:95], v228 offset:41984
    buffer_load_dwordx4 a[184:187], v6, s[24:27], s69 offen offset:0 sc1
    v_mfma_f32_16x16x32_bf16 v[56:59], v[112:115], v[156:159], v[56:59]
    s_waitcnt lgkmcnt(12)
    v_mfma_f32_16x16x32_bf16 v[40:43], v[116:119], v[152:155], v[40:43]
    ds_read_b64_tr_b16 v[96:97], v229 offset:40960
    ds_read_b64_tr_b16 v[98:99], v229 offset:41984
    v_mfma_f32_16x16x32_bf16 v[60:63], v[116:119], v[156:159], v[60:63]
    buffer_load_dwordx4 a[188:191], v6, s[24:27], s69 offen offset:1024 sc1
    s_waitcnt lgkmcnt(12)
    v_mfma_f32_16x16x32_bf16 v[24:27], v[120:123], v[160:163], v[24:27]
    ds_read_b64_tr_b16 v[100:101], v230 offset:40960
    ds_read_b64_tr_b16 v[102:103], v230 offset:41984
    v_mfma_f32_16x16x32_bf16 v[44:47], v[120:123], v[164:167], v[44:47]
    s_waitcnt lgkmcnt(12)
    v_mfma_f32_16x16x32_bf16 v[28:31], v[124:127], v[160:163], v[28:31]
    ds_read_b64_tr_b16 v[104:105], v231 offset:40960
    ds_read_b64_tr_b16 v[106:107], v231 offset:41984
    v_mfma_f32_16x16x32_bf16 v[48:51], v[124:127], v[164:167], v[48:51]
    buffer_load_dwordx4 a[192:195], v6, s[24:27], s69 offen offset:2048 sc1
    s_waitcnt lgkmcnt(12)
    v_mfma_f32_16x16x32_bf16 v[32:35], v[80:83], v[160:163], v[32:35]
    ds_read_b64_tr_b16 v[108:109], v236 offset:2048
    ds_read_b64_tr_b16 v[110:111], v236 offset:2304
    v_mfma_f32_16x16x32_bf16 v[52:55], v[80:83], v[164:167], v[52:55]
    s_waitcnt lgkmcnt(12)
    v_mfma_f32_16x16x32_bf16 v[36:39], v[84:87], v[160:163], v[36:39]
    ds_read_b64_tr_b16 v[112:113], v228 offset:45056
    ds_read_b64_tr_b16 v[114:115], v228 offset:46080
    buffer_load_dwordx4 a[196:199], v6, s[24:27], s69 offen offset:3072 sc1
    v_mfma_f32_16x16x32_bf16 v[56:59], v[84:87], v[164:167], v[56:59]
    s_waitcnt lgkmcnt(12)
    v_mfma_f32_16x16x32_bf16 v[40:43], v[88:91], v[160:163], v[40:43]
    ds_read_b64_tr_b16 v[116:117], v229 offset:45056
    ds_read_b64_tr_b16 v[118:119], v229 offset:46080
    v_mfma_f32_16x16x32_bf16 v[60:63], v[88:91], v[164:167], v[60:63]
    s_waitcnt vmcnt(9)
    s_barrier
    s_waitcnt vmcnt(8)
    buffer_store_dwordx2 v[22:23], v224, s[24:27], 0 offen offset:64
    buffer_store_dwordx2 v[22:23], v226, s[24:27], s23 offen offset:64 sc1
    ds_read_b64_tr_b16 a[0:1], v232 offset:24576
    ds_read_b64_tr_b16 a[2:3], v232 offset:25600
    buffer_load_dwordx4 a[200:203], v6, s[24:27], s70 offen offset:0 sc1
    ds_read_b64_tr_b16 a[4:5], v233 offset:24576
    ds_read_b64_tr_b16 a[6:7], v233 offset:25600
    ds_read_b64_tr_b16 a[8:9], v234 offset:24576
    ds_read_b64_tr_b16 a[10:11], v234 offset:25600
    ds_read_b64_tr_b16 a[12:13], v232 offset:28672
    ds_read_b64_tr_b16 a[14:15], v232 offset:29696
    ds_read_b64_tr_b16 a[16:17], v233 offset:28672
    ds_read_b64_tr_b16 a[18:19], v233 offset:29696
    ds_read_b64_tr_b16 a[20:21], v234 offset:28672
    ds_read_b64_tr_b16 a[22:23], v234 offset:29696
    ds_read_b64_tr_b16 a[24:25], v228 offset:0
    ds_read_b64_tr_b16 a[26:27], v228 offset:1024
    ds_read_b64_tr_b16 a[28:29], v229 offset:0
    ds_read_b64_tr_b16 a[30:31], v229 offset:1024
    ds_read_b64_tr_b16 a[32:33], v230 offset:0
    ds_read_b64_tr_b16 a[34:35], v230 offset:1024
    s_waitcnt vmcnt(10) lgkmcnt(15)
    v_mfma_f32_16x16x32_bf16 v[24:27], v[92:95], a[168:171], v[24:27]
    ds_read_b64_tr_b16 v[120:121], v230 offset:45056
    ds_read_b64_tr_b16 v[122:123], v230 offset:46080
    s_waitcnt vmcnt(9)
    v_mfma_f32_16x16x32_bf16 v[44:47], v[92:95], a[172:175], v[44:47]
    v_and_b32 v4, 0xffff0000, v22
    v_mfma_f32_16x16x32_bf16 v[28:31], v[96:99], a[168:171], v[28:31]
    ds_read_b64_tr_b16 v[124:125], v231 offset:45056
    ds_read_b64_tr_b16 v[126:127], v231 offset:46080
    v_mfma_f32_16x16x32_bf16 v[48:51], v[96:99], a[172:175], v[48:51]
    v_mov_b32 v187, v22
    v_mfma_f32_16x16x32_bf16 v[32:35], v[100:103], a[168:171], v[32:35]
    ds_read_b64_tr_b16 v[80:81], v236 offset:3072
    ds_read_b64_tr_b16 v[82:83], v236 offset:3328
    buffer_load_dwordx4 a[204:207], v6, s[24:27], s70 offen offset:2048 sc1
    v_mfma_f32_16x16x32_bf16 v[52:55], v[100:103], a[172:175], v[52:55]
    s_mov_b32 s74, 0xffff
    v_mfma_f32_16x16x32_bf16 v[36:39], v[104:107], a[168:171], v[36:39]
    ds_read_b64_tr_b16 v[84:85], v232 offset:16384
    ds_read_b64_tr_b16 v[86:87], v232 offset:17408
    v_mfma_f32_16x16x32_bf16 v[56:59], v[104:107], a[172:175], v[56:59]
    v_mfma_f32_16x16x32_bf16 v[40:43], v[108:111], a[168:171], v[40:43]
    ds_read_b64_tr_b16 v[88:89], v233 offset:16384
    ds_read_b64_tr_b16 v[90:91], v233 offset:17408
    v_mfma_f32_16x16x32_bf16 v[60:63], v[108:111], a[172:175], v[60:63]
    buffer_load_dwordx4 a[208:211], v6, s[24:27], s71 offen offset:0 sc1
    s_waitcnt vmcnt(10)
    v_mfma_f32_16x16x32_bf16 v[24:27], v[112:115], a[176:179], v[24:27]
    ds_read_b64_tr_b16 v[92:93], v234 offset:16384
    ds_read_b64_tr_b16 v[94:95], v234 offset:17408
    s_waitcnt vmcnt(9)
    v_mfma_f32_16x16x32_bf16 v[44:47], v[112:115], a[180:183], v[44:47]
    v_mfma_f32_16x16x32_bf16 v[28:31], v[116:119], a[176:179], v[28:31]
    ds_read_b64_tr_b16 v[96:97], v235 offset:16384
    ds_read_b64_tr_b16 v[98:99], v235 offset:17408
    v_mfma_f32_16x16x32_bf16 v[48:51], v[116:119], a[180:183], v[48:51]
    s_waitcnt lgkmcnt(12)
    v_mfma_f32_16x16x32_bf16 v[32:35], v[120:123], a[176:179], v[32:35]
    ds_read_b64_tr_b16 v[100:101], v236 offset:8192
    ds_read_b64_tr_b16 v[102:103], v236 offset:8448
    buffer_load_dwordx4 a[212:215], v6, s[24:27], s71 offen offset:2048 sc1
    v_mfma_f32_16x16x32_bf16 v[52:55], v[120:123], a[180:183], v[52:55]
    s_waitcnt lgkmcnt(12)
    v_mfma_f32_16x16x32_bf16 v[36:39], v[124:127], a[176:179], v[36:39]
    ds_read_b64_tr_b16 v[104:105], v232 offset:20480
    ds_read_b64_tr_b16 v[106:107], v232 offset:21504
    v_mfma_f32_16x16x32_bf16 v[56:59], v[124:127], a[180:183], v[56:59]
    s_waitcnt lgkmcnt(12)
    v_mfma_f32_16x16x32_bf16 v[40:43], v[80:83], a[176:179], v[40:43]
    ds_read_b64_tr_b16 v[108:109], v233 offset:20480
    ds_read_b64_tr_b16 v[110:111], v233 offset:21504
    v_mfma_f32_16x16x32_bf16 v[60:63], v[80:83], a[180:183], v[60:63]
    buffer_load_dwordx4 a[216:219], v6, s[24:27], s29 offen offset:0 sc1
    s_waitcnt vmcnt(10) lgkmcnt(12)
    v_mfma_f32_16x16x32_bf16 v[24:27], v[84:87], a[184:187], v[24:27]
    ds_read_b64_tr_b16 v[112:113], v234 offset:20480
    ds_read_b64_tr_b16 v[114:115], v234 offset:21504
    s_waitcnt vmcnt(9)
    v_mfma_f32_16x16x32_bf16 v[44:47], v[84:87], a[188:191], v[44:47]
    s_waitcnt lgkmcnt(12)
    v_mfma_f32_16x16x32_bf16 v[28:31], v[88:91], a[184:187], v[28:31]
    ds_read_b64_tr_b16 v[116:117], v235 offset:20480
    ds_read_b64_tr_b16 v[118:119], v235 offset:21504
    v_mfma_f32_16x16x32_bf16 v[48:51], v[88:91], a[188:191], v[48:51]
    s_waitcnt lgkmcnt(12)
    v_mfma_f32_16x16x32_bf16 v[32:35], v[92:95], a[184:187], v[32:35]
    ds_read_b64_tr_b16 v[120:121], v236 offset:9216
    ds_read_b64_tr_b16 v[122:123], v236 offset:9472
    buffer_load_dwordx4 a[220:223], v6, s[24:27], s29 offen offset:2048 sc1
    v_mfma_f32_16x16x32_bf16 v[52:55], v[92:95], a[188:191], v[52:55]
    s_waitcnt lgkmcnt(12)
    v_mfma_f32_16x16x32_bf16 v[36:39], v[96:99], a[184:187], v[36:39]
    ds_read_b64_tr_b16 v[124:125], v235 offset:24576
    ds_read_b64_tr_b16 v[126:127], v235 offset:25600
    v_mfma_f32_16x16x32_bf16 v[56:59], v[96:99], a[188:191], v[56:59]
    s_waitcnt lgkmcnt(12)
    v_mfma_f32_16x16x32_bf16 v[40:43], v[100:103], a[184:187], v[40:43]
    ds_read_b64_tr_b16 v[80:81], v236 offset:10240
    ds_read_b64_tr_b16 v[82:83], v236 offset:10496
    v_mfma_f32_16x16x32_bf16 v[60:63], v[100:103], a[188:191], v[60:63]
    buffer_load_dwordx4 a[224:227], v6, s[24:27], s30 offen offset:0 sc1
    s_waitcnt vmcnt(10) lgkmcnt(12)
    v_mfma_f32_16x16x32_bf16 v[24:27], v[104:107], a[192:195], v[24:27]
    s_buffer_load_dwordx16 s[84:99], s[24:27], s22 offset:64
    ds_read_b64_tr_b16 v[84:85], v235 offset:28672
    ds_read_b64_tr_b16 v[86:87], v235 offset:29696
    s_waitcnt vmcnt(9)
    v_mfma_f32_16x16x32_bf16 v[44:47], v[104:107], a[196:199], v[44:47]
    s_waitcnt lgkmcnt(12)
    v_mfma_f32_16x16x32_bf16 v[28:31], v[108:111], a[192:195], v[28:31]
    ds_read_b64_tr_b16 v[88:89], v236 offset:11264
    ds_read_b64_tr_b16 v[90:91], v236 offset:11520
    v_mfma_f32_16x16x32_bf16 v[48:51], v[108:111], a[196:199], v[48:51]
    s_waitcnt lgkmcnt(12)
    v_mfma_f32_16x16x32_bf16 v[32:35], v[112:115], a[192:195], v[32:35]
    ds_read_b64_tr_b16 v[92:93], v231 offset:0
    ds_read_b64_tr_b16 v[94:95], v231 offset:1024
    buffer_load_dwordx4 a[228:231], v6, s[24:27], s30 offen offset:2048 sc1
    v_mfma_f32_16x16x32_bf16 v[52:55], v[112:115], a[196:199], v[52:55]
    s_waitcnt lgkmcnt(12)
    v_mfma_f32_16x16x32_bf16 v[36:39], v[116:119], a[192:195], v[36:39]
    ds_read_b64_tr_b16 v[96:97], v236 offset:12288
    ds_read_b64_tr_b16 v[98:99], v236 offset:12544
    v_mfma_f32_16x16x32_bf16 v[56:59], v[116:119], a[196:199], v[56:59]
    s_waitcnt lgkmcnt(12)
    v_mfma_f32_16x16x32_bf16 v[40:43], v[120:123], a[192:195], v[40:43]
    ds_read_b64_tr_b16 a[36:37], v228 offset:4096
    ds_read_b64_tr_b16 a[38:39], v228 offset:5120
    v_mfma_f32_16x16x32_bf16 v[60:63], v[120:123], a[196:199], v[60:63]
    buffer_load_dwordx4 a[232:235], v6, s[24:27], s31 offen offset:0 sc1
    s_waitcnt vmcnt(8)
    v_mfma_f32_16x16x32_bf16 v[24:27], a[0:3], a[200:203], v[24:27]
    v_mfma_f32_16x16x32_bf16 v[28:31], a[4:7], a[200:203], v[28:31]
    s_waitcnt lgkmcnt(12)
    v_mfma_f32_16x16x32_bf16 v[32:35], a[8:11], a[200:203], v[32:35]
    v_mfma_f32_16x16x32_bf16 v[36:39], v[124:127], a[200:203], v[36:39]
    ds_read_b64_tr_b16 a[40:41], v229 offset:4096
    ds_read_b64_tr_b16 a[42:43], v229 offset:5120
    s_waitcnt lgkmcnt(12)
    v_mfma_f32_16x16x32_bf16 v[40:43], v[80:83], a[200:203], v[40:43]
    ds_read_b64_tr_b16 a[44:45], v230 offset:4096
    ds_read_b64_tr_b16 a[46:47], v230 offset:5120
    buffer_load_dwordx4 a[236:239], v6, s[24:27], s31 offen offset:2048 sc1
    s_waitcnt vmcnt(8)
    v_mfma_f32_16x16x32_bf16 v[24:27], a[12:15], a[204:207], v[24:27]
    v_mfma_f32_16x16x32_bf16 v[28:31], a[16:19], a[204:207], v[28:31]
    v_mfma_f32_16x16x32_bf16 v[32:35], a[20:23], a[204:207], v[32:35]
    s_waitcnt lgkmcnt(10)
    v_mfma_f32_16x16x32_bf16 v[36:39], v[84:87], a[204:207], v[36:39]
    s_waitcnt lgkmcnt(0)
    s_xor_b64 s[86:87], s[86:87], s[20:21]
    s_xor_b64 s[88:89], s[88:89], s[20:21]
    s_xor_b64 s[90:91], s[90:91], s[20:21]
    s_xor_b64 s[92:93], s[92:93], s[20:21]
    s_xor_b64 s[94:95], s[94:95], s[20:21]
    s_xor_b64 s[96:97], s[96:97], s[20:21]
    s_xor_b64 s[98:99], s[98:99], s[20:21]
    s_or_b64 s[86:87], s[86:87], s[88:89]
    s_or_b64 s[86:87], s[86:87], s[90:91]
    s_or_b64 s[86:87], s[86:87], s[92:93]
    s_or_b64 s[86:87], s[86:87], s[94:95]
    s_or_b64 s[86:87], s[86:87], s[96:97]
    s_or_b64 s[86:87], s[86:87], s[98:99]
    s_cbranch_scc1 L_sr
L_sb:
    ds_read_b64_tr_b16 v[100:101], v231 offset:4096
    ds_read_b64_tr_b16 v[102:103], v231 offset:5120
    buffer_load_dwordx4 a[240:243], v7, s[24:27], s68 offen offset:0 sc1
    v_mfma_f32_16x16x32_bf16 v[40:43], v[88:91], a[204:207], v[40:43]
    ds_read_b64_tr_b16 v[104:105], v236 offset:13312
    ds_read_b64_tr_b16 v[106:107], v236 offset:13568
    buffer_load_dwordx4 a[244:247], v7, s[24:27], s69 offen offset:0 sc1
    s_waitcnt vmcnt(9)
    v_mfma_f32_16x16x32_bf16 v[24:27], a[24:27], a[208:211], v[24:27]
    v_mfma_f32_16x16x32_bf16 v[28:31], a[28:31], a[208:211], v[28:31]
    buffer_load_dwordx4 a[248:251], v7, s[24:27], s70 offen offset:0 sc1
    v_mfma_f32_16x16x32_bf16 v[32:35], a[32:35], a[208:211], v[32:35]
    v_mfma_f32_16x16x32_bf16 v[36:39], v[92:95], a[208:211], v[36:39]
    ds_read_b64_tr_b16 a[48:49], v228 offset:8192
    ds_read_b64_tr_b16 a[50:51], v228 offset:9216
    buffer_load_dwordx4 a[252:255], v7, s[24:27], s71 offen offset:0 sc1
    v_mfma_f32_16x16x32_bf16 v[40:43], v[96:99], a[208:211], v[40:43]
    ds_read_b64_tr_b16 a[52:53], v229 offset:8192
    ds_read_b64_tr_b16 a[54:55], v229 offset:9216
    buffer_load_dwordx4 v[200:203], v7, s[24:27], s29 offen offset:0 sc1
    s_waitcnt vmcnt(11)
    v_mfma_f32_16x16x32_bf16 v[24:27], a[36:39], a[212:215], v[24:27]
    ds_read_b64_tr_b16 a[56:57], v230 offset:8192
    ds_read_b64_tr_b16 a[58:59], v230 offset:9216
    v_mfma_f32_16x16x32_bf16 v[28:31], a[40:43], a[212:215], v[28:31]
    ds_read_b64_tr_b16 v[108:109], v231 offset:8192
    ds_read_b64_tr_b16 v[110:111], v231 offset:9216
    buffer_load_dwordx4 v[204:207], v7, s[24:27], s30 offen offset:0 sc1
    v_mfma_f32_16x16x32_bf16 v[32:35], a[44:47], a[212:215], v[32:35]
    ds_read_b64_tr_b16 v[112:113], v236 offset:14336
    ds_read_b64_tr_b16 v[114:115], v236 offset:14592
    s_waitcnt lgkmcnt(10)
    v_mfma_f32_16x16x32_bf16 v[36:39], v[100:103], a[212:215], v[36:39]
    ds_read_b64_tr_b16 a[60:61], v228 offset:12288
    ds_read_b64_tr_b16 a[62:63], v228 offset:13312
    buffer_load_dwordx4 v[208:211], v7, s[24:27], s31 offen offset:0 sc1
    v_mfma_f32_16x16x32_bf16 v[40:43], v[104:107], a[212:215], v[40:43]
    ds_read_b64_tr_b16 a[64:65], v229 offset:12288
    ds_read_b64_tr_b16 a[66:67], v229 offset:13312
    buffer_load_dwordx4 v[212:215], v6, s[24:27], s70 offen offset:1024 sc1
    s_waitcnt vmcnt(13) lgkmcnt(10)
    v_mfma_f32_16x16x32_bf16 v[24:27], a[48:51], a[216:219], v[24:27]
    ds_read_b64_tr_b16 a[68:69], v230 offset:12288
    ds_read_b64_tr_b16 a[70:71], v230 offset:13312
    v_mfma_f32_16x16x32_bf16 v[28:31], a[52:55], a[216:219], v[28:31]
    ds_read_b64_tr_b16 v[116:117], v231 offset:12288
    ds_read_b64_tr_b16 v[118:119], v231 offset:13312
    s_waitcnt lgkmcnt(10)
    v_mfma_f32_16x16x32_bf16 v[32:35], a[56:59], a[216:219], v[32:35]
    ds_read_b64_tr_b16 v[120:121], v236 offset:15360
    ds_read_b64_tr_b16 v[122:123], v236 offset:15616
    v_mfma_f32_16x16x32_bf16 v[36:39], v[108:111], a[216:219], v[36:39]
    ds_read_b64_tr_b16 a[72:73], v228 offset:16384
    ds_read_b64_tr_b16 a[74:75], v228 offset:17408
    s_waitcnt lgkmcnt(10)
    v_mfma_f32_16x16x32_bf16 v[40:43], v[112:115], a[216:219], v[40:43]
    ds_read_b64_tr_b16 a[76:77], v229 offset:16384
    ds_read_b64_tr_b16 a[78:79], v229 offset:17408
    buffer_load_dwordx4 v[216:219], v6, s[24:27], s70 offen offset:3072 sc1
    s_waitcnt vmcnt(13)
    v_mfma_f32_16x16x32_bf16 v[24:27], a[60:63], a[220:223], v[24:27]
    ds_read_b64_tr_b16 a[80:81], v230 offset:16384
    ds_read_b64_tr_b16 a[82:83], v230 offset:17408
    s_waitcnt lgkmcnt(10)
    v_mfma_f32_16x16x32_bf16 v[28:31], a[64:67], a[220:223], v[28:31]
    ds_read_b64_tr_b16 v[124:125], v231 offset:16384
    ds_read_b64_tr_b16 v[126:127], v231 offset:17408
    v_mfma_f32_16x16x32_bf16 v[32:35], a[68:71], a[220:223], v[32:35]
    ds_read_b64_tr_b16 v[80:81], v236 offset:16384
    ds_read_b64_tr_b16 v[82:83], v236 offset:16640
    s_waitcnt lgkmcnt(10)
    v_mfma_f32_16x16x32_bf16 v[36:39], v[116:119], a[220:223], v[36:39]
    ds_read_b64_tr_b16 a[84:85], v228 offset:20480
    ds_read_b64_tr_b16 a[86:87], v228 offset:21504
    v_mfma_f32_16x16x32_bf16 v[40:43], v[120:123], a[220:223], v[40:43]
    ds_read_b64_tr_b16 a[88:89], v229 offset:20480
    ds_read_b64_tr_b16 a[90:91], v229 offset:21504
    buffer_load_dwordx4 v[220:223], v6, s[24:27], s71 offen offset:1024 sc1
    s_waitcnt vmcnt(13) lgkmcnt(10)
    v_mfma_f32_16x16x32_bf16 v[24:27], a[72:75], a[224:227], v[24:27]
    ds_read_b64_tr_b16 a[92:93], v230 offset:20480
    ds_read_b64_tr_b16 a[94:95], v230 offset:21504
    v_mfma_f32_16x16x32_bf16 v[28:31], a[76:79], a[224:227], v[28:31]
    ds_read_b64_tr_b16 v[84:85], v231 offset:20480
    ds_read_b64_tr_b16 v[86:87], v231 offset:21504
    s_waitcnt lgkmcnt(10)
    v_mfma_f32_16x16x32_bf16 v[32:35], a[80:83], a[224:227], v[32:35]
    ds_read_b64_tr_b16 v[88:89], v236 offset:17408
    ds_read_b64_tr_b16 v[90:91], v236 offset:17664
    v_mfma_f32_16x16x32_bf16 v[36:39], v[124:127], a[224:227], v[36:39]
    ds_read_b64_tr_b16 a[96:97], v228 offset:24576
    ds_read_b64_tr_b16 a[98:99], v228 offset:25600
    s_waitcnt lgkmcnt(10)
    v_mfma_f32_16x16x32_bf16 v[40:43], v[80:83], a[224:227], v[40:43]
    ds_read_b64_tr_b16 a[100:101], v229 offset:24576
    ds_read_b64_tr_b16 a[102:103], v229 offset:25600
    buffer_load_dwordx4 v[240:243], v6, s[24:27], s71 offen offset:3072 sc1
    s_waitcnt vmcnt(13)
    v_mfma_f32_16x16x32_bf16 v[24:27], a[84:87], a[228:231], v[24:27]
    ds_read_b64_tr_b16 v[92:93], v230 offset:24576
    ds_read_b64_tr_b16 v[94:95], v230 offset:25600
    s_waitcnt lgkmcnt(10)
    v_mfma_f32_16x16x32_bf16 v[28:31], a[88:91], a[228:231], v[28:31]
    ds_read_b64_tr_b16 v[96:97], v231 offset:24576
    ds_read_b64_tr_b16 v[98:99], v231 offset:25600
    v_mfma_f32_16x16x32_bf16 v[32:35], a[92:95], a[228:231], v[32:35]
    ds_read_b64_tr_b16 v[100:101], v236 offset:18432
    ds_read_b64_tr_b16 v[102:103], v236 offset:18688
    s_waitcnt lgkmcnt(10)
    v_mfma_f32_16x16x32_bf16 v[36:39], v[84:87], a[228:231], v[36:39]
    ds_read_b64_tr_b16 a[104:105], v228 offset:28672
    ds_read_b64_tr_b16 a[106:107], v228 offset:29696
    v_mfma_f32_16x16x32_bf16 v[40:43], v[88:91], a[228:231], v[40:43]
    ds_read_b64_tr_b16 a[108:109], v229 offset:28672
    ds_read_b64_tr_b16 a[110:111], v229 offset:29696
    buffer_load_dwordx4 v[244:247], v6, s[24:27], s29 offen offset:1024 sc1
    s_waitcnt vmcnt(13) lgkmcnt(10)
    v_mfma_f32_16x16x32_bf16 v[24:27], a[96:99], a[232:235], v[24:27]
    ds_read_b64_tr_b16 v[104:105], v230 offset:28672
    ds_read_b64_tr_b16 v[106:107], v230 offset:29696
    v_mfma_f32_16x16x32_bf16 v[28:31], a[100:103], a[232:235], v[28:31]
    ds_read_b64_tr_b16 v[108:109], v231 offset:28672
    ds_read_b64_tr_b16 v[110:111], v231 offset:29696
    s_waitcnt lgkmcnt(10)
    v_mfma_f32_16x16x32_bf16 v[32:35], v[92:95], a[232:235], v[32:35]
    ds_read_b64_tr_b16 v[112:113], v236 offset:19456
    ds_read_b64_tr_b16 v[114:115], v236 offset:19712
    v_mfma_f32_16x16x32_bf16 v[36:39], v[96:99], a[232:235], v[36:39]
    ds_read_b64_tr_b16 v[116:117], v230 offset:53248
    ds_read_b64_tr_b16 v[118:119], v230 offset:54272
    s_waitcnt lgkmcnt(10)
    v_mfma_f32_16x16x32_bf16 v[40:43], v[100:103], a[232:235], v[40:43]
    ds_read_b64_tr_b16 v[120:121], v231 offset:53248
    ds_read_b64_tr_b16 v[122:123], v231 offset:54272
    buffer_load_dwordx4 v[248:251], v6, s[24:27], s29 offen offset:3072 sc1
    s_waitcnt vmcnt(13)
    v_mfma_f32_16x16x32_bf16 v[24:27], a[104:107], a[236:239], v[24:27]
    ds_read_b64_tr_b16 v[124:125], v236 offset:5120
    ds_read_b64_tr_b16 v[126:127], v236 offset:5376
    s_waitcnt lgkmcnt(10)
    v_mfma_f32_16x16x32_bf16 v[28:31], a[108:111], a[236:239], v[28:31]
    ds_read_b64_tr_b16 v[80:81], v230 offset:57344
    ds_read_b64_tr_b16 v[82:83], v230 offset:58368
    v_mfma_f32_16x16x32_bf16 v[32:35], v[104:107], a[236:239], v[32:35]
    ds_read_b64_tr_b16 v[84:85], v231 offset:57344
    ds_read_b64_tr_b16 v[86:87], v231 offset:58368
    s_waitcnt lgkmcnt(10)
    v_mfma_f32_16x16x32_bf16 v[36:39], v[108:111], a[236:239], v[36:39]
    ds_read_b64_tr_b16 v[88:89], v236 offset:6144
    ds_read_b64_tr_b16 v[90:91], v236 offset:6400
    v_mfma_f32_16x16x32_bf16 v[40:43], v[112:115], a[236:239], v[40:43]
    ds_read_b64_tr_b16 v[92:93], v230 offset:61440
    ds_read_b64_tr_b16 v[94:95], v230 offset:62464
    buffer_load_dwordx4 v[252:255], v6, s[24:27], s30 offen offset:1024 sc1
    s_waitcnt vmcnt(13)
    v_mfma_f32_16x16x32_bf16 v[24:27], a[112:115], a[240:243], v[24:27]
    v_mfma_f32_16x16x32_bf16 v[28:31], a[116:119], a[240:243], v[28:31]
    s_waitcnt lgkmcnt(10)
    v_mfma_f32_16x16x32_bf16 v[32:35], v[116:119], a[240:243], v[32:35]
    ds_read_b64_tr_b16 v[96:97], v231 offset:61440
    ds_read_b64_tr_b16 v[98:99], v231 offset:62464
    v_mfma_f32_16x16x32_bf16 v[36:39], v[120:123], a[240:243], v[36:39]
    ds_read_b64_tr_b16 v[100:101], v236 offset:7168
    ds_read_b64_tr_b16 v[102:103], v236 offset:7424
    s_waitcnt lgkmcnt(12)
    v_mfma_f32_16x16x32_bf16 v[40:43], v[124:127], a[240:243], v[40:43]
    ds_read_b64_tr_b16 a[136:137], v232 offset:0
    ds_read_b64_tr_b16 a[138:139], v232 offset:1024
    buffer_load_dwordx4 v[168:171], v6, s[24:27], s30 offen offset:3072 sc1
    s_waitcnt vmcnt(13)
    v_mfma_f32_16x16x32_bf16 v[24:27], a[120:123], a[244:247], v[24:27]
    s_waitcnt lgkmcnt(12)
    v_mfma_f32_16x16x32_bf16 v[28:31], a[124:127], a[244:247], v[28:31]
    v_mfma_f32_16x16x32_bf16 v[32:35], v[80:83], a[244:247], v[32:35]
    ds_read_b64_tr_b16 a[140:141], v233 offset:0
    ds_read_b64_tr_b16 a[142:143], v233 offset:1024
    s_waitcnt lgkmcnt(10)
    v_mfma_f32_16x16x32_bf16 v[36:39], v[84:87], a[244:247], v[36:39]
    ds_read_b64_tr_b16 v[104:105], v234 offset:0
    ds_read_b64_tr_b16 v[106:107], v234 offset:1024
    v_mfma_f32_16x16x32_bf16 v[40:43], v[88:91], a[244:247], v[40:43]
    ds_read_b64_tr_b16 v[108:109], v235 offset:0
    ds_read_b64_tr_b16 v[110:111], v235 offset:1024
    buffer_load_dwordx4 v[172:175], v6, s[24:27], s31 offen offset:1024 sc1
    s_waitcnt vmcnt(13)
    v_mfma_f32_16x16x32_bf16 v[24:27], a[128:131], a[248:251], v[24:27]
    v_mfma_f32_16x16x32_bf16 v[28:31], a[132:135], a[248:251], v[28:31]
    s_waitcnt lgkmcnt(10)
    v_mfma_f32_16x16x32_bf16 v[32:35], v[92:95], a[248:251], v[32:35]
    ds_read_b64_tr_b16 v[112:113], v236 offset:20480
    ds_read_b64_tr_b16 v[114:115], v236 offset:20736
    v_mfma_f32_16x16x32_bf16 v[36:39], v[96:99], a[248:251], v[36:39]
    ds_read_b64_tr_b16 a[144:145], v232 offset:4096
    ds_read_b64_tr_b16 a[146:147], v232 offset:5120
    s_waitcnt lgkmcnt(10)
    v_mfma_f32_16x16x32_bf16 v[40:43], v[100:103], a[248:251], v[40:43]
    ds_read_b64_tr_b16 a[148:149], v233 offset:4096
    ds_read_b64_tr_b16 a[150:151], v233 offset:5120
    buffer_load_dwordx4 v[64:67], v6, s[24:27], s31 offen offset:3072 sc1
    s_waitcnt vmcnt(13)
    v_mfma_f32_16x16x32_bf16 v[24:27], a[136:139], a[252:255], v[24:27]
    ds_read_b64_tr_b16 v[116:117], v234 offset:4096
    ds_read_b64_tr_b16 v[118:119], v234 offset:5120
    s_waitcnt lgkmcnt(10)
    v_mfma_f32_16x16x32_bf16 v[28:31], a[140:143], a[252:255], v[28:31]
    ds_read_b64_tr_b16 v[120:121], v235 offset:4096
    ds_read_b64_tr_b16 v[122:123], v235 offset:5120
    v_mfma_f32_16x16x32_bf16 v[32:35], v[104:107], a[252:255], v[32:35]
    ds_read_b64_tr_b16 v[124:125], v236 offset:21504
    ds_read_b64_tr_b16 v[126:127], v236 offset:21760
    s_waitcnt lgkmcnt(10)
    v_mfma_f32_16x16x32_bf16 v[36:39], v[108:111], a[252:255], v[36:39]
    ds_read_b64_tr_b16 a[152:153], v232 offset:8192
    ds_read_b64_tr_b16 a[154:155], v232 offset:9216
    v_mfma_f32_16x16x32_bf16 v[40:43], v[112:115], a[252:255], v[40:43]
    ds_read_b64_tr_b16 a[156:157], v233 offset:8192
    ds_read_b64_tr_b16 a[158:159], v233 offset:9216
    buffer_load_dwordx4 v[68:71], v7, s[24:27], s68 offen offset:1024 sc1
    s_waitcnt vmcnt(13) lgkmcnt(10)
    v_mfma_f32_16x16x32_bf16 v[24:27], a[144:147], v[200:203], v[24:27]
    ds_read_b64_tr_b16 v[80:81], v234 offset:8192
    ds_read_b64_tr_b16 v[82:83], v234 offset:9216
    v_mfma_f32_16x16x32_bf16 v[28:31], a[148:151], v[200:203], v[28:31]
    ds_read_b64_tr_b16 v[84:85], v235 offset:8192
    ds_read_b64_tr_b16 v[86:87], v235 offset:9216
    s_waitcnt lgkmcnt(10)
    v_mfma_f32_16x16x32_bf16 v[32:35], v[116:119], v[200:203], v[32:35]
    ds_read_b64_tr_b16 v[88:89], v236 offset:22528
    ds_read_b64_tr_b16 v[90:91], v236 offset:22784
    v_mfma_f32_16x16x32_bf16 v[36:39], v[120:123], v[200:203], v[36:39]
    ds_read_b64_tr_b16 a[160:161], v232 offset:12288
    ds_read_b64_tr_b16 a[162:163], v232 offset:13312
    s_waitcnt lgkmcnt(10)
    v_mfma_f32_16x16x32_bf16 v[40:43], v[124:127], v[200:203], v[40:43]
    ds_read_b64_tr_b16 a[164:165], v233 offset:12288
    ds_read_b64_tr_b16 a[166:167], v233 offset:13312
    buffer_load_dwordx4 v[72:75], v7, s[24:27], s69 offen offset:1024 sc1
    s_waitcnt vmcnt(13)
    v_mfma_f32_16x16x32_bf16 v[24:27], a[152:155], v[204:207], v[24:27]
    ds_read_b64_tr_b16 v[92:93], v234 offset:12288
    ds_read_b64_tr_b16 v[94:95], v234 offset:13312
    s_waitcnt lgkmcnt(10)
    v_mfma_f32_16x16x32_bf16 v[28:31], a[156:159], v[204:207], v[28:31]
    ds_read_b64_tr_b16 v[96:97], v235 offset:12288
    ds_read_b64_tr_b16 v[98:99], v235 offset:13312
    v_mfma_f32_16x16x32_bf16 v[32:35], v[80:83], v[204:207], v[32:35]
    ds_read_b64_tr_b16 v[100:101], v236 offset:23552
    ds_read_b64_tr_b16 v[102:103], v236 offset:23808
    s_waitcnt lgkmcnt(10)
    v_mfma_f32_16x16x32_bf16 v[36:39], v[84:87], v[204:207], v[36:39]
    ds_read_b64_tr_b16 v[104:105], v235 offset:24576
    ds_read_b64_tr_b16 v[106:107], v235 offset:25600
    v_mfma_f32_16x16x32_bf16 v[40:43], v[88:91], v[204:207], v[40:43]
    ds_read_b64_tr_b16 v[108:109], v236 offset:10240
    ds_read_b64_tr_b16 v[110:111], v236 offset:10496
    buffer_load_dwordx4 v[76:79], v7, s[24:27], s70 offen offset:1024 sc1
    s_waitcnt vmcnt(13) lgkmcnt(10)
    v_mfma_f32_16x16x32_bf16 v[24:27], a[160:163], v[208:211], v[24:27]
    ds_read_b64_tr_b16 v[112:113], v235 offset:28672
    ds_read_b64_tr_b16 v[114:115], v235 offset:29696
    v_mfma_f32_16x16x32_bf16 v[28:31], a[164:167], v[208:211], v[28:31]
    ds_read_b64_tr_b16 v[116:117], v236 offset:11264
    ds_read_b64_tr_b16 v[118:119], v236 offset:11520
    s_waitcnt lgkmcnt(10)
    v_mfma_f32_16x16x32_bf16 v[32:35], v[92:95], v[208:211], v[32:35]
    ds_read_b64_tr_b16 v[120:121], v231 offset:0
    ds_read_b64_tr_b16 v[122:123], v231 offset:1024
    v_mfma_f32_16x16x32_bf16 v[36:39], v[96:99], v[208:211], v[36:39]
    ds_read_b64_tr_b16 v[124:125], v236 offset:12288
    ds_read_b64_tr_b16 v[126:127], v236 offset:12544
    v_cvt_pk_bf16_f32 v176, v24, v25
    v_cvt_pk_bf16_f32 v177, v26, v27
    s_waitcnt lgkmcnt(12)
    v_mfma_f32_16x16x32_bf16 v[40:43], v[100:103], v[208:211], v[40:43]
    ds_read_b64_tr_b16 v[80:81], v231 offset:4096
    ds_read_b64_tr_b16 v[82:83], v231 offset:5120
    buffer_load_dwordx4 v[128:131], v7, s[24:27], s71 offen offset:1024 sc1
    v_cvt_pk_bf16_f32 v178, v28, v29
    v_cvt_pk_bf16_f32 v179, v30, v30
    s_waitcnt vmcnt(13)
    v_mfma_f32_16x16x32_bf16 v[44:47], a[0:3], v[212:215], v[44:47]
    v_cvt_pk_bf16_f32 v183, v31, v31
    v_and_or_b32 v179, v179, s74, v4
    v_mfma_f32_16x16x32_bf16 v[48:51], a[4:7], v[212:215], v[48:51]
    v_and_or_b32 v183, v183, s74, v4
    buffer_store_dwordx4 v[176:179], v6, s[24:27], s66 offen offset:0 sc1
    v_mfma_f32_16x16x32_bf16 v[52:55], a[8:11], v[212:215], v[52:55]
    v_cvt_pk_bf16_f32 v180, v32, v33
    v_cvt_pk_bf16_f32 v181, v34, v35
    s_waitcnt lgkmcnt(10)
    v_mfma_f32_16x16x32_bf16 v[56:59], v[104:107], v[212:215], v[56:59]
    ds_read_b64_tr_b16 v[84:85], v236 offset:13312
    ds_read_b64_tr_b16 v[86:87], v236 offset:13568
    v_cvt_pk_bf16_f32 v182, v36, v37
    v_cvt_pk_bf16_f32 v184, v38, v39
    v_mfma_f32_16x16x32_bf16 v[60:63], v[108:111], v[212:215], v[60:63]
    ds_read_b64_tr_b16 v[88:89], v231 offset:8192
    ds_read_b64_tr_b16 v[90:91], v231 offset:9216
    buffer_load_dwordx4 v[132:135], v7, s[24:27], s29 offen offset:1024 sc1
    buffer_store_dwordx4 v[180:183], v6, s[24:27], s66 offen offset:1024 sc1
    v_cvt_pk_bf16_f32 v185, v40, v41
    s_waitcnt vmcnt(15)
    v_mfma_f32_16x16x32_bf16 v[44:47], a[12:15], v[216:219], v[44:47]
    s_or_b32 s34, s2, s28
    s_mov_b32 s35, 8912896
    s_cselect_b32 s35, 0x40000000, s35
    v_lshlrev_b32 v2, 9, v1
    buffer_load_dwordx2 v[144:145], v2, s[24:27], s35 offen offset:0 sc1
    buffer_load_dwordx2 v[146:147], v2, s[24:27], s35 offen offset:128 sc1
    buffer_load_dwordx2 v[148:149], v2, s[24:27], s35 offen offset:256 sc1
    buffer_load_dwordx2 v[150:151], v2, s[24:27], s35 offen offset:384 sc1
    v_cvt_pk_bf16_f32 v186, v42, v43
    s_nop 0
    v_mfma_f32_16x16x32_bf16 v[48:51], a[16:19], v[216:219], v[48:51]
    buffer_store_dwordx4 v[184:187], v6, s[24:27], s66 offen offset:2048 sc1
    s_waitcnt lgkmcnt(12)
    v_mfma_f32_16x16x32_bf16 v[52:55], a[20:23], v[216:219], v[52:55]
    v_mfma_f32_16x16x32_bf16 v[56:59], v[112:115], v[216:219], v[56:59]
    ds_read_b64_tr_b16 v[92:93], v236 offset:14336
    ds_read_b64_tr_b16 v[94:95], v236 offset:14592
    s_waitcnt lgkmcnt(12)
    v_mfma_f32_16x16x32_bf16 v[60:63], v[116:119], v[216:219], v[60:63]
    ds_read_b64_tr_b16 v[96:97], v231 offset:12288
    ds_read_b64_tr_b16 v[98:99], v231 offset:13312
    buffer_load_dwordx4 v[136:139], v7, s[24:27], s30 offen offset:1024 sc1
    s_waitcnt vmcnt(20)
    v_mfma_f32_16x16x32_bf16 v[44:47], a[24:27], v[220:223], v[44:47]
    v_mfma_f32_16x16x32_bf16 v[48:51], a[28:31], v[220:223], v[48:51]
    v_mfma_f32_16x16x32_bf16 v[52:55], a[32:35], v[220:223], v[52:55]
    s_waitcnt lgkmcnt(10)
    v_mfma_f32_16x16x32_bf16 v[56:59], v[120:123], v[220:223], v[56:59]
    ds_read_b64_tr_b16 v[100:101], v236 offset:15360
    ds_read_b64_tr_b16 v[102:103], v236 offset:15616
    v_mfma_f32_16x16x32_bf16 v[60:63], v[124:127], v[220:223], v[60:63]
    ds_read_b64_tr_b16 v[104:105], v231 offset:16384
    ds_read_b64_tr_b16 v[106:107], v231 offset:17408
    buffer_load_dwordx4 v[140:143], v7, s[24:27], s31 offen offset:1024 sc1
    s_waitcnt vmcnt(20)
    v_mfma_f32_16x16x32_bf16 v[44:47], a[36:39], v[240:243], v[44:47]
    v_mfma_f32_16x16x32_bf16 v[48:51], a[40:43], v[240:243], v[48:51]
    s_waitcnt lgkmcnt(12)
    v_mfma_f32_16x16x32_bf16 v[52:55], a[44:47], v[240:243], v[52:55]
    v_mfma_f32_16x16x32_bf16 v[56:59], v[80:83], v[240:243], v[56:59]
    ds_read_b64_tr_b16 v[108:109], v236 offset:16384
    ds_read_b64_tr_b16 v[110:111], v236 offset:16640
    s_waitcnt lgkmcnt(12)
    v_mfma_f32_16x16x32_bf16 v[60:63], v[84:87], v[240:243], v[60:63]
    ds_read_b64_tr_b16 v[112:113], v231 offset:20480
    ds_read_b64_tr_b16 v[114:115], v231 offset:21504
    s_waitcnt vmcnt(19)
    v_mfma_f32_16x16x32_bf16 v[44:47], a[48:51], v[244:247], v[44:47]
    v_mfma_f32_16x16x32_bf16 v[48:51], a[52:55], v[244:247], v[48:51]
    v_mfma_f32_16x16x32_bf16 v[52:55], a[56:59], v[244:247], v[52:55]
    s_waitcnt lgkmcnt(10)
    v_mfma_f32_16x16x32_bf16 v[56:59], v[88:91], v[244:247], v[56:59]
    ds_read_b64_tr_b16 v[116:117], v236 offset:17408
    ds_read_b64_tr_b16 v[118:119], v236 offset:17664
    v_mfma_f32_16x16x32_bf16 v[60:63], v[92:95], v[244:247], v[60:63]
    ds_read_b64_tr_b16 v[120:121], v230 offset:24576
    ds_read_b64_tr_b16 v[122:123], v230 offset:25600
    s_waitcnt vmcnt(18)
    v_mfma_f32_16x16x32_bf16 v[44:47], a[60:63], v[248:251], v[44:47]
    v_mfma_f32_16x16x32_bf16 v[48:51], a[64:67], v[248:251], v[48:51]
    s_waitcnt lgkmcnt(12)
    v_mfma_f32_16x16x32_bf16 v[52:55], a[68:71], v[248:251], v[52:55]
    v_mfma_f32_16x16x32_bf16 v[56:59], v[96:99], v[248:251], v[56:59]
    ds_read_b64_tr_b16 v[124:125], v231 offset:24576
    ds_read_b64_tr_b16 v[126:127], v231 offset:25600
    s_waitcnt lgkmcnt(12)
    v_mfma_f32_16x16x32_bf16 v[60:63], v[100:103], v[248:251], v[60:63]
    ds_read_b64_tr_b16 v[80:81], v236 offset:18432
    ds_read_b64_tr_b16 v[82:83], v236 offset:18688
    s_waitcnt vmcnt(17)
    v_mfma_f32_16x16x32_bf16 v[44:47], a[72:75], v[252:255], v[44:47]
    v_mfma_f32_16x16x32_bf16 v[48:51], a[76:79], v[252:255], v[48:51]
    v_mfma_f32_16x16x32_bf16 v[52:55], a[80:83], v[252:255], v[52:55]
    s_waitcnt lgkmcnt(10)
    v_mfma_f32_16x16x32_bf16 v[56:59], v[104:107], v[252:255], v[56:59]
    ds_read_b64_tr_b16 v[84:85], v230 offset:28672
    ds_read_b64_tr_b16 v[86:87], v230 offset:29696
    v_mfma_f32_16x16x32_bf16 v[60:63], v[108:111], v[252:255], v[60:63]
    ds_read_b64_tr_b16 v[88:89], v231 offset:28672
    ds_read_b64_tr_b16 v[90:91], v231 offset:29696
    s_waitcnt vmcnt(16)
    v_mfma_f32_16x16x32_bf16 v[44:47], a[84:87], v[168:171], v[44:47]
    v_mfma_f32_16x16x32_bf16 v[48:51], a[88:91], v[168:171], v[48:51]
    s_waitcnt lgkmcnt(12)
    v_mfma_f32_16x16x32_bf16 v[52:55], a[92:95], v[168:171], v[52:55]
    v_mfma_f32_16x16x32_bf16 v[56:59], v[112:115], v[168:171], v[56:59]
    ds_read_b64_tr_b16 v[92:93], v236 offset:19456
    ds_read_b64_tr_b16 v[94:95], v236 offset:19712
    s_waitcnt lgkmcnt(12)
    v_mfma_f32_16x16x32_bf16 v[60:63], v[116:119], v[168:171], v[60:63]
    ds_read_b64_tr_b16 v[96:97], v230 offset:53248
    ds_read_b64_tr_b16 v[98:99], v230 offset:54272
    s_waitcnt vmcnt(15)
    v_mfma_f32_16x16x32_bf16 v[44:47], a[96:99], v[172:175], v[44:47]
    s_waitcnt lgkmcnt(12)
    v_mfma_f32_16x16x32_bf16 v[48:51], a[100:103], v[172:175], v[48:51]
    v_mfma_f32_16x16x32_bf16 v[52:55], v[120:123], v[172:175], v[52:55]
    ds_read_b64_tr_b16 v[100:101], v231 offset:53248
    ds_read_b64_tr_b16 v[102:103], v231 offset:54272
    s_waitcnt lgkmcnt(10)
    v_mfma_f32_16x16x32_bf16 v[56:59], v[124:127], v[172:175], v[56:59]
    ds_read_b64_tr_b16 v[104:105], v236 offset:5120
    ds_read_b64_tr_b16 v[106:107], v236 offset:5376
    v_mfma_f32_16x16x32_bf16 v[60:63], v[80:83], v[172:175], v[60:63]
    ds_read_b64_tr_b16 v[108:109], v230 offset:57344
    ds_read_b64_tr_b16 v[110:111], v230 offset:58368
    s_waitcnt vmcnt(14)
    v_mfma_f32_16x16x32_bf16 v[44:47], a[104:107], v[64:67], v[44:47]
    v_mfma_f32_16x16x32_bf16 v[48:51], a[108:111], v[64:67], v[48:51]
    s_waitcnt lgkmcnt(10)
    v_mfma_f32_16x16x32_bf16 v[52:55], v[84:87], v[64:67], v[52:55]
    ds_read_b64_tr_b16 v[112:113], v231 offset:57344
    ds_read_b64_tr_b16 v[114:115], v231 offset:58368
    v_mfma_f32_16x16x32_bf16 v[56:59], v[88:91], v[64:67], v[56:59]
    ds_read_b64_tr_b16 v[116:117], v236 offset:6144
    ds_read_b64_tr_b16 v[118:119], v236 offset:6400
    s_waitcnt lgkmcnt(12)
    v_mfma_f32_16x16x32_bf16 v[60:63], v[92:95], v[64:67], v[60:63]
    ds_read_b64_tr_b16 v[120:121], v230 offset:61440
    ds_read_b64_tr_b16 v[122:123], v230 offset:62464
    s_waitcnt vmcnt(13)
    v_mfma_f32_16x16x32_bf16 v[44:47], a[112:115], v[68:71], v[44:47]
    s_waitcnt lgkmcnt(12)
    v_mfma_f32_16x16x32_bf16 v[48:51], a[116:119], v[68:71], v[48:51]
    v_mfma_f32_16x16x32_bf16 v[52:55], v[96:99], v[68:71], v[52:55]
    ds_read_b64_tr_b16 v[124:125], v231 offset:61440
    ds_read_b64_tr_b16 v[126:127], v231 offset:62464
    s_waitcnt lgkmcnt(10)
    v_mfma_f32_16x16x32_bf16 v[56:59], v[100:103], v[68:71], v[56:59]
    ds_read_b64_tr_b16 v[80:81], v236 offset:7168
    ds_read_b64_tr_b16 v[82:83], v236 offset:7424
    v_mfma_f32_16x16x32_bf16 v[60:63], v[104:107], v[68:71], v[60:63]
    ds_read_b64_tr_b16 v[84:85], v234 offset:0
    ds_read_b64_tr_b16 v[86:87], v234 offset:1024
    s_waitcnt vmcnt(12)
    v_mfma_f32_16x16x32_bf16 v[44:47], a[120:123], v[72:75], v[44:47]
    v_mfma_f32_16x16x32_bf16 v[48:51], a[124:127], v[72:75], v[48:51]
    s_waitcnt lgkmcnt(10)
    v_mfma_f32_16x16x32_bf16 v[52:55], v[108:111], v[72:75], v[52:55]
    ds_read_b64_tr_b16 v[88:89], v235 offset:0
    ds_read_b64_tr_b16 v[90:91], v235 offset:1024
    v_mfma_f32_16x16x32_bf16 v[56:59], v[112:115], v[72:75], v[56:59]
    ds_read_b64_tr_b16 v[92:93], v236 offset:20480
    ds_read_b64_tr_b16 v[94:95], v236 offset:20736
    s_waitcnt lgkmcnt(12)
    v_mfma_f32_16x16x32_bf16 v[60:63], v[116:119], v[72:75], v[60:63]
    ds_read_b64_tr_b16 v[96:97], v234 offset:4096
    ds_read_b64_tr_b16 v[98:99], v234 offset:5120
    s_waitcnt vmcnt(11)
    v_mfma_f32_16x16x32_bf16 v[44:47], a[128:131], v[76:79], v[44:47]
    s_waitcnt lgkmcnt(12)
    v_mfma_f32_16x16x32_bf16 v[48:51], a[132:135], v[76:79], v[48:51]
    v_mfma_f32_16x16x32_bf16 v[52:55], v[120:123], v[76:79], v[52:55]
    ds_read_b64_tr_b16 v[100:101], v235 offset:4096
    ds_read_b64_tr_b16 v[102:103], v235 offset:5120
    s_waitcnt lgkmcnt(10)
    v_mfma_f32_16x16x32_bf16 v[56:59], v[124:127], v[76:79], v[56:59]
    ds_read_b64_tr_b16 v[104:105], v236 offset:21504
    ds_read_b64_tr_b16 v[106:107], v236 offset:21760
    v_mfma_f32_16x16x32_bf16 v[60:63], v[80:83], v[76:79], v[60:63]
    ds_read_b64_tr_b16 v[108:109], v234 offset:8192
    ds_read_b64_tr_b16 v[110:111], v234 offset:9216
    s_waitcnt vmcnt(10)
    v_mfma_f32_16x16x32_bf16 v[44:47], a[136:139], v[128:131], v[44:47]
    v_mfma_f32_16x16x32_bf16 v[48:51], a[140:143], v[128:131], v[48:51]
    s_waitcnt lgkmcnt(10)
    v_mfma_f32_16x16x32_bf16 v[52:55], v[84:87], v[128:131], v[52:55]
    ds_read_b64_tr_b16 v[112:113], v235 offset:8192
    ds_read_b64_tr_b16 v[114:115], v235 offset:9216
    v_mfma_f32_16x16x32_bf16 v[56:59], v[88:91], v[128:131], v[56:59]
    ds_read_b64_tr_b16 v[116:117], v236 offset:22528
    ds_read_b64_tr_b16 v[118:119], v236 offset:22784
    s_waitcnt lgkmcnt(12)
    v_mfma_f32_16x16x32_bf16 v[60:63], v[92:95], v[128:131], v[60:63]
    ds_read_b64_tr_b16 v[120:121], v234 offset:12288
    ds_read_b64_tr_b16 v[122:123], v234 offset:13312
    s_waitcnt vmcnt(8)
    v_mfma_f32_16x16x32_bf16 v[44:47], a[144:147], v[132:135], v[44:47]
    buffer_load_dwordx4 v[188:191], v6, s[24:27], s67 offen offset:0 sc1
    s_waitcnt lgkmcnt(12)
    v_mfma_f32_16x16x32_bf16 v[48:51], a[148:151], v[132:135], v[48:51]
    buffer_load_dwordx4 v[192:195], v6, s[24:27], s67 offen offset:1024 sc1
    v_mfma_f32_16x16x32_bf16 v[52:55], v[96:99], v[132:135], v[52:55]
    buffer_load_dwordx4 v[196:199], v6, s[24:27], s67 offen offset:2048 sc1
    ds_read_b64_tr_b16 v[124:125], v235 offset:12288
    ds_read_b64_tr_b16 v[126:127], v235 offset:13312
    s_waitcnt lgkmcnt(10)
    v_mfma_f32_16x16x32_bf16 v[56:59], v[100:103], v[132:135], v[56:59]
    ds_read_b64_tr_b16 v[80:81], v236 offset:23552
    ds_read_b64_tr_b16 v[82:83], v236 offset:23808
    v_mfma_f32_16x16x32_bf16 v[60:63], v[104:107], v[132:135], v[60:63]
    s_waitcnt vmcnt(4)
    v_mfma_f32_16x16x32_bf16 v[44:47], a[152:155], v[136:139], v[44:47]
    v_mfma_f32_16x16x32_bf16 v[48:51], a[156:159], v[136:139], v[48:51]
    s_waitcnt lgkmcnt(8)
    v_mfma_f32_16x16x32_bf16 v[52:55], v[108:111], v[136:139], v[52:55]
    v_mfma_f32_16x16x32_bf16 v[56:59], v[112:115], v[136:139], v[56:59]
    s_waitcnt lgkmcnt(6)
    v_mfma_f32_16x16x32_bf16 v[60:63], v[116:119], v[136:139], v[60:63]
    s_waitcnt vmcnt(3)
    v_mfma_f32_16x16x32_bf16 v[44:47], a[160:163], v[140:143], v[44:47]
    s_waitcnt lgkmcnt(4)
    v_mfma_f32_16x16x32_bf16 v[48:51], a[164:167], v[140:143], v[48:51]
    v_mfma_f32_16x16x32_bf16 v[52:55], v[120:123], v[140:143], v[52:55]
    s_waitcnt lgkmcnt(0)
    v_mfma_f32_16x16x32_bf16 v[56:59], v[124:127], v[140:143], v[56:59]
    v_mfma_f32_16x16x32_bf16 v[60:63], v[80:83], v[140:143], v[60:63]
    s_mov_b32 s75, 0x40000
    s_waitcnt vmcnt(0)
    v_xor_b32 v2, v191, v22
    v_xor_b32 v3, v195, v22
    v_or_b32 v2, v2, v3
    v_xor_b32 v3, v199, v22
    v_lshrrev_b32 v2, 16, v2
    v_or_b32 v2, v2, v3
    v_cmp_ne_u32 vcc, 0, v2
    s_nop 1
    s_cbranch_vccnz L_xr
L_xb:
    v_lshlrev_b32 v80, 16, v188
    v_and_b32 v81, 0xffff0000, v188
    v_lshlrev_b32 v82, 16, v189
    v_and_b32 v83, 0xffff0000, v189
    v_lshlrev_b32 v84, 16, v190
    v_and_b32 v85, 0xffff0000, v190
    v_lshlrev_b32 v86, 16, v191
    v_lshlrev_b32 v87, 16, v195
    v_lshlrev_b32 v88, 16, v192
    v_and_b32 v89, 0xffff0000, v192
    v_lshlrev_b32 v90, 16, v193
    v_and_b32 v91, 0xffff0000, v193
    v_lshlrev_b32 v92, 16, v194
    v_and_b32 v93, 0xffff0000, v194
    v_lshlrev_b32 v94, 16, v196
    v_and_b32 v95, 0xffff0000, v196
    v_lshlrev_b32 v96, 16, v197
    v_and_b32 v97, 0xffff0000, v197
    v_lshlrev_b32 v98, 16, v198
    v_and_b32 v99, 0xffff0000, v198
    v_pk_add_f32 v[44:45], v[44:45], v[80:81]
    v_pk_add_f32 v[46:47], v[46:47], v[82:83]
    v_pk_add_f32 v[48:49], v[48:49], v[84:85]
    v_pk_add_f32 v[50:51], v[50:51], v[86:87]
    v_pk_add_f32 v[52:53], v[52:53], v[88:89]
    v_pk_add_f32 v[54:55], v[54:55], v[90:91]
    v_pk_add_f32 v[56:57], v[56:57], v[92:93]
    v_pk_add_f32 v[58:59], v[58:59], v[94:95]
    v_pk_add_f32 v[60:61], v[60:61], v[96:97]
    v_pk_add_f32 v[62:63], v[62:63], v[98:99]
    v_cvt_pk_bf16_f32 v24, v44, v45
    v_cvt_pk_bf16_f32 v25, v46, v47
    v_cvt_pk_bf16_f32 v26, v48, v49
    v_cvt_pk_bf16_f32 v27, v50, v51
    v_cvt_pk_bf16_f32 v28, v52, v53
    v_cvt_pk_bf16_f32 v29, v54, v55
    v_cvt_pk_bf16_f32 v30, v56, v57
    v_cvt_pk_bf16_f32 v31, v58, v59
    v_cvt_pk_bf16_f32 v32, v60, v61
    v_cvt_pk_bf16_f32 v33, v62, v63
    v_permlane16_swap_b32 v24, v26
    v_permlane16_swap_b32 v25, v27
    v_permlane16_swap_b32 v28, v30
    v_permlane16_swap_b32 v29, v31
    buffer_store_dwordx4 v[24:27], v18, s[16:19], s72 offen nt
    buffer_store_dwordx4 v[28:31], v18, s[16:19], s72 offen offset:64 nt
    buffer_store_dwordx2 v[32:33], v19, s[16:19], s72 offen nt
    s_or_b32 s34, s2, s28
    s_cbranch_scc0 L_ep
L_noep:
L_end:
    s_endpgm
L_pr:
    s_mov_b32 s75, 8
L_pr1:
    buffer_load_dwordx2 v[20:21], v5, s[24:27], 0 offen sc1
    s_waitcnt vmcnt(0)
    v_cmp_ne_u64 vcc, v[20:21], v[22:23]
    s_nop 1
    s_cbranch_vccz L_pb
    s_sub_u32 s75, s75, 1
    s_cbranch_scc0 L_pr1
    v_and_b32 v2, 7, v1
    v_lshlrev_b32 v2, 7, v2
    s_and_b32 s34, s23, 0xfffffc00
    s_mov_b32 s75, 0x40000
L_pr2:
    buffer_load_dwordx2 v[20:21], v2, s[24:27], s34 offen sc1
    s_waitcnt vmcnt(0)
    v_cmp_ne_u64 vcc, v[20:21], v[22:23]
    s_sub_u32 s75, s75, 1
    s_cbranch_scc1 L_pb
    s_cbranch_vccnz L_pr2
    s_branch L_pb
L_sr:
    s_mov_b32 s75, 8
L_sr1:
    buffer_load_dwordx2 v[20:21], v5, s[24:27], 0 offen offset:64 sc1
    s_waitcnt vmcnt(0)
    v_cmp_ne_u64 vcc, v[20:21], v[22:23]
    s_nop 1
    s_cbranch_vccz L_sb
    s_sub_u32 s75, s75, 1
    s_cbranch_scc0 L_sr1
    v_and_b32 v2, 7, v1
    v_lshlrev_b32 v2, 7, v2
    s_and_b32 s34, s23, 0xfffffc00
    s_mov_b32 s75, 0x40000
L_sr2:
    buffer_load_dwordx2 v[20:21], v2, s[24:27], s34 offen offset:64 sc1
    s_waitcnt vmcnt(0)
    v_cmp_ne_u64 vcc, v[20:21], v[22:23]
    s_sub_u32 s75, s75, 1
    s_cbranch_scc1 L_sb
    s_cbranch_vccnz L_sr2
    s_branch L_sb
L_xr:
    buffer_load_dwordx4 v[188:191], v6, s[24:27], s67 offen offset:0 sc1
    buffer_load_dwordx4 v[192:195], v6, s[24:27], s67 offen offset:1024 sc1
    buffer_load_dwordx4 v[196:199], v6, s[24:27], s67 offen offset:2048 sc1
    s_waitcnt vmcnt(0)
    v_xor_b32 v2, v191, v22
    v_xor_b32 v3, v195, v22
    v_or_b32 v2, v2, v3
    v_xor_b32 v3, v199, v22
    v_lshrrev_b32 v2, 16, v2
    v_or_b32 v2, v2, v3
    v_cmp_ne_u32 vcc, 0, v2
    s_sub_u32 s75, s75, 1
    s_cbranch_scc1 L_xb
    s_cbranch_vccnz L_xr
    s_branch L_xb
L_ep:
    s_mov_b32 s75, 0x40000
    s_mov_b32 s35, 8912896
    s_branch L_chk_t
L_chk:
    v_lshlrev_b32 v2, 9, v1
    buffer_load_dwordx2 v[144:145], v2, s[24:27], s35 offen offset:0 sc1
    buffer_load_dwordx2 v[146:147], v2, s[24:27], s35 offen offset:128 sc1
    buffer_load_dwordx2 v[148:149], v2, s[24:27], s35 offen offset:256 sc1
    buffer_load_dwordx2 v[150:151], v2, s[24:27], s35 offen offset:384 sc1
    s_waitcnt vmcnt(0)
L_chk_t:
    v_xor_b32 v144, v144, v22
    v_xor_b32 v145, v145, v23
    v_xor_b32 v146, v146, v22
    v_xor_b32 v147, v147, v23
    v_xor_b32 v148, v148, v22
    v_xor_b32 v149, v149, v23
    v_xor_b32 v150, v150, v22
    v_xor_b32 v151, v151, v23
    v_or3_b32 v144, v144, v145, v146
    v_or3_b32 v147, v147, v148, v149
    v_or3_b32 v144, v144, v150, v151
    v_or_b32 v144, v144, v147
    v_cmp_ne_u32 vcc, 0, v144
    s_sub_u32 s75, s75, 1
    s_cbranch_scc1 L_chk_d
    s_cbranch_vccnz L_chk
L_chk_d:
    v_or_b32 v2, s2, v0
    v_lshlrev_b32 v2, 25, v2
    v_add_u32 v2, 8945664, v2
    buffer_store_dwordx2 v[22:23], v2, s[24:27], 0 offen sc1
    s_branch L_noep
L_code_end:
.section .rodata,"a"
.p2align 6
.amdhsa_kernel standalone__dense_activation_silu__prompt_kernel
  .amdhsa_next_free_vgpr 512
  .amdhsa_next_free_sgpr 102
  .amdhsa_accum_offset 256
  .amdhsa_group_segment_fixed_size 0
  .amdhsa_kernarg_size 48
  .amdhsa_user_sgpr_count 2
  .amdhsa_user_sgpr_kernarg_segment_ptr 1
  .amdhsa_system_sgpr_workgroup_id_x 1
.end_amdhsa_kernel
```
